```python
import torch

def _softmax(x, axis=-1):
    return torch.softmax(x, dim=axis)
def _gelu(x):
    return torch.nn.functional.gelu(x, approximate="tanh")
def _silu(x):
    return torch.nn.functional.silu(x)
def _sigmoid(x):
    return torch.sigmoid(x)
def _layernorm(x, axis=-1, eps=1e-5):
    m = x.mean(dim=axis, keepdim=True)
    v = x.var(dim=axis, keepdim=True, unbiased=False)
    return (x - m) / torch.sqrt(v + eps)
def _scatter_add(tgt, idx, src, axis=0):
    return tgt.clone().index_add_(axis, idx, src)
def _segment_sum(src, seg, n):
    out = torch.zeros((n,) + src.shape[1:], dtype=src.dtype)
    return out.index_add_(0, seg, src)
def _pad(x, pw):
    flat = tuple(v for pair in reversed(pw) for v in pair)
    return torch.nn.functional.pad(x, flat)

kernel_name = 'recurrent_scan__spectral_fnet__mixer_channel_mlp__prompt'

def setup_inputs():

    _w = (lambda a: (lambda t: t.to(torch.bfloat16) if t.is_floating_point() else t)(torch.as_tensor(a)))
    def _A_setup():
        B, S, D = 1, 2048, 512
        ns = torch.arange(S)[:, None] * torch.arange(S)[None, :]
        nd = torch.arange(D)[:, None] * torch.arange(D)[None, :]
        Ws_re = torch.cos(-2.0 * torch.pi * ns / S).to(float)
        Ws_im = torch.sin(-2.0 * torch.pi * ns / S).to(float)
        Wd_re = torch.cos(-2.0 * torch.pi * nd / D).to(float)
        Wd_im = torch.sin(-2.0 * torch.pi * nd / D).to(float)
        return {
            "x": _w((lambda *s: torch.randn(*s, dtype=torch.bfloat16) * 0.05)(B, S, D)),
            "dft_seq_re": _w(Ws_re),
            "dft_seq_im": _w(Ws_im),
            "dft_hid_re": _w(Wd_re),
            "dft_hid_im": _w(Wd_im),
        }
    _A_in = _A_setup()

    def _B_setup():
        B, S, D, F = 1, 2048, 512, 1792
        return {
            "x": _w((lambda *s: torch.randn(*s, dtype=torch.bfloat16) * 0.05)(B, S, D)),
            "w1": _w((lambda *s: torch.randn(*s, dtype=torch.bfloat16) * 0.8)(D, F) * (D ** -0.5)),
            "b1": _w((lambda *s: torch.randn(*s, dtype=torch.bfloat16) * 0.4)(F)),
            "w2": _w((lambda *s: torch.randn(*s, dtype=torch.bfloat16) * 0.05)(F, D) * (F ** -0.5)),
            "b2": _w((lambda *s: torch.randn(*s, dtype=torch.bfloat16) * 0.05)(D)),
        }
    _B_in = _B_setup()

    return {
        "A_x": _A_in["x"],
        "A_dft_seq_re": _A_in["dft_seq_re"],
        "A_dft_seq_im": _A_in["dft_seq_im"],
        "A_dft_hid_re": _A_in["dft_hid_re"],
        "A_dft_hid_im": _A_in["dft_hid_im"],
        "B_x": _B_in["x"],
        "B_w1": _B_in["w1"],
        "B_b1": _B_in["b1"],
        "B_w2": _B_in["w2"],
        "B_b2": _B_in["b2"],
    }

def reference(A_x, A_dft_seq_re, A_dft_seq_im, A_dft_hid_re, A_dft_hid_im, B_x, B_w1, B_b1, B_w2, B_b2):
    def _A_ref(x, dft_seq_re, dft_seq_im, dft_hid_re, dft_hid_im):
        a = torch.einsum("bsd,ed->bse", x, dft_hid_re)
        b = torch.einsum("bsd,ed->bse", x, dft_hid_im)
        y = torch.einsum("ts,bse->bte", dft_seq_re, a) - torch.einsum("ts,bse->bte", dft_seq_im, b)
        return y

    def _B_ref(x, w1, b1, w2, b2):
        y = _layernorm(x, axis=-1)
        h = _gelu(torch.einsum("bsd,df->bsf", y, w1) + b1)
        return torch.einsum("bsf,fd->bsd", h, w2) + b2

    x = A_x
    xn = _layernorm(x, axis=-1)
    s = _A_ref(xn, A_dft_seq_re, A_dft_seq_im, A_dft_hid_re, A_dft_hid_im)
    g = _silu(_B_ref(xn, B_w1, B_b1, B_w2, B_b2))
    return x + s * g
```

```asm
; @launch grid=(256,1,1) block=(256,1,1) lds=163840
.amdgcn_target "amdgcn-amd-amdhsa--gfx950"
.text
.globl recurrent_scan__spectral_fnet__mixer_channel_mlp__prompt_kernel
.p2align 8
.type recurrent_scan__spectral_fnet__mixer_channel_mlp__prompt_kernel,@function
recurrent_scan__spectral_fnet__mixer_channel_mlp__prompt_kernel:
    s_cmp_ge_u32 s2, 256
    s_cbranch_scc1 L_end
    s_load_dwordx16 s[4:19], s[0:1], 0
    s_load_dwordx8 s[20:27], s[0:1], 64
    s_load_dwordx2 s[28:29], s[0:1], 96
    v_lshrrev_b32 v1, 6, v0
    s_and_b32 s30, s2, 7
    s_lshr_b32 s31, s2, 3
    v_readfirstlane_b32 s3, v1
    s_getpc_b64 s[50:51]
L_pc:
    s_mul_i32 s53, s31, 1280
    v_lshl_add_u32 v2, v0, 3, s53
    v_min_u32 v2, L_codeend-L_pc-4, v2
    v_mov_b32 v3, s51
    v_add_co_u32 v2, vcc, s50, v2
    s_nop 1
    v_addc_co_u32 v3, vcc, 0, v3, vcc
    global_load_dword v1, v[2:3], off
    v_and_b32 v0, 63, v0
    s_lshr_b32 s48, s30, 1
    s_lshl_b32 s55, s48, 1
    s_lshl_b32 s48, s48, 2
    s_and_b32 s100, s31, 3
    s_add_u32 s48, s48, s100
    s_lshr_b32 s49, s31, 2
    s_sub_u32 s49, s49, 1
    s_and_b32 s49, s49, 7
    s_add_u32 s56, s100, s49
    s_and_b32 s56, s56, 3
    s_lshl_b32 s56, s56, 1
    s_and_b32 s53, s30, 1
    s_cmp_eq_u32 s49, 7
    s_cbranch_scc1 L_dfte
    s_mul_i32 s54, s53, 7
    s_add_u32 s49, s49, s54
    s_and_b32 s50, s3, 1
    s_lshr_b32 s51, s3, 1
    s_lshl_b32 s63, s48, 1
    s_add_u32 s63, s63, s53
    s_sub_u32 s53, 32, s48
    s_cmp_eq_u32 s48, 0
    s_cselect_b32 s53, 16, s53
    s_cmp_eq_u32 s51, 0
    s_cselect_b32 s52, s48, s53
    v_lshrrev_b32 v24, 3, v0
    v_lshrrev_b32 v25, 4, v0
    v_and_b32 v28, 7, v0
    v_xor_b32 v26, v28, v25
    v_lshlrev_b32 v26, 4, v26
    v_lshl_add_u32 v26, v24, 15, v26
    s_lshl_b32 s53, s52, 10
    s_lshl_b32 s54, s50, 20
    s_add_u32 s53, s53, s54
    v_add_u32 v2, s53, v26
    v_xor_b32 v27, 64, v2
    v_add_u32 v3, 261120, v27
    v_add_u32 v4, 522240, v2
    v_add_u32 v5, 783360, v27
    v_and_b32 v26, 15, v0
    v_lshlrev_b32 v27, 2, v25
    v_xor_b32 v26, v26, v27
    v_lshlrev_b32 v26, 4, v26
    v_mul_u32_u24 v29, 3584, v25
    v_add_u32 v26, v26, v29
    s_mul_i32 s53, s3, 57344
    s_lshl_b32 s54, s49, 8
    s_add_u32 s53, s53, s54
    v_add_u32 v6, s53, v26
    v_add_u32 v7, 13312, v6
    v_add_u32 v8, 26624, v6
    v_add_u32 v9, 39936, v6
    s_lshl_b32 s55, s3, 12
    s_waitcnt lgkmcnt(0)
    s_mov_b32 s32, s4
    s_mov_b32 s33, s5
    s_mov_b32 s34, 2097152
    s_mov_b32 s35, 0x20000
    s_mov_b32 s36, s16
    s_mov_b32 s37, s17
    s_mov_b32 s38, 1835008
    s_mov_b32 s39, 0x20000
    s_lshl_b32 s57, s56, 7
    s_mul_i32 s58, s56, 229376
    s_add_u32 m0, s55, 0
    s_nop 0
    buffer_load_dwordx4 v2, s[32:35], s57 offen offset:0 lds
    buffer_load_dwordx4 v3, s[32:35], s57 offen offset:1024 lds
    buffer_load_dwordx4 v4, s[32:35], s57 offen offset:2048 lds
    buffer_load_dwordx4 v5, s[32:35], s57 offen offset:3072 lds
    s_add_u32 m0, s55, 16384
    s_add_u32 s56, s56, 1
    s_and_b32 s56, s56, 7
    buffer_load_dwordx4 v6, s[36:39], s58 offen offset:0 lds
    buffer_load_dwordx4 v7, s[36:39], s58 offen offset:1024 lds
    buffer_load_dwordx4 v8, s[36:39], s58 offen offset:2048 lds
    buffer_load_dwordx4 v9, s[36:39], s58 offen offset:3072 lds
    s_lshl_b32 s57, s56, 7
    s_mul_i32 s58, s56, 229376
    s_add_u32 m0, s55, 32768
    s_nop 0
    buffer_load_dwordx4 v2, s[32:35], s57 offen offset:0 lds
    buffer_load_dwordx4 v3, s[32:35], s57 offen offset:1024 lds
    buffer_load_dwordx4 v4, s[32:35], s57 offen offset:2048 lds
    buffer_load_dwordx4 v5, s[32:35], s57 offen offset:3072 lds
    s_add_u32 m0, s55, 49152
    s_add_u32 s56, s56, 1
    s_and_b32 s56, s56, 7
    buffer_load_dwordx4 v6, s[36:39], s58 offen offset:0 lds
    buffer_load_dwordx4 v7, s[36:39], s58 offen offset:1024 lds
    s_branch L_mlp
L_dfte:
    s_mov_b32 s49, s53
    s_lshr_b32 s51, s3, 1
    s_sub_u32 s53, 32, s48
    s_cmp_eq_u32 s48, 0
    s_cselect_b32 s53, 16, s53
    s_cmp_eq_u32 s51, 0
    s_cselect_b32 s52, s48, s53
    s_and_b32 s50, s3, 1
    s_lshl_b32 s53, s50, 5
    s_add_u32 s53, s53, s52
    s_lshl_b32 s53, s53, 10
    v_lshrrev_b32 v24, 3, v0
    v_lshrrev_b32 v25, 4, v0
    v_and_b32 v26, 7, v0
    v_lshlrev_b32 v27, 4, v26
    v_lshl_add_u32 v27, v24, 16, v27
    s_lshl_b32 s54, s100, 7
    v_add3_u32 v57, v27, s53, 0
    v_add_u32 v57, s54, v57
    v_xor_b32 v18, 0x80, v57
    v_xor_b32 v19, 0x100, v57
    v_xor_b32 v2, 0x180, v57
    s_waitcnt lgkmcnt(0)
    s_mov_b32 s32, s4
    s_mov_b32 s33, s5
    s_mov_b32 s34, 2097152
    s_mov_b32 s35, 0x20000
    s_mov_b32 s58, 0
    buffer_load_dwordx4 v[64:67], v57, s[32:35], s58 offen offset:0
    buffer_load_dwordx4 v[68:71], v18, s[32:35], s58 offen offset:0
    buffer_load_dwordx4 v[72:75], v19, s[32:35], s58 offen offset:0
    buffer_load_dwordx4 v[76:79], v2, s[32:35], s58 offen offset:0
    buffer_load_dwordx4 v[80:83], v57, s[32:35], s58 offen offset:512
    buffer_load_dwordx4 v[84:87], v18, s[32:35], s58 offen offset:512
    buffer_load_dwordx4 v[88:91], v19, s[32:35], s58 offen offset:512
    buffer_load_dwordx4 v[92:95], v2, s[32:35], s58 offen offset:512
    s_mov_b32 s58, 524288
    buffer_load_dwordx4 v[96:99], v57, s[32:35], s58 offen offset:0
    buffer_load_dwordx4 v[100:103], v18, s[32:35], s58 offen offset:0
    buffer_load_dwordx4 v[104:107], v19, s[32:35], s58 offen offset:0
    buffer_load_dwordx4 v[108:111], v2, s[32:35], s58 offen offset:0
    buffer_load_dwordx4 v[112:115], v57, s[32:35], s58 offen offset:512
    buffer_load_dwordx4 v[116:119], v18, s[32:35], s58 offen offset:512
    buffer_load_dwordx4 v[120:123], v19, s[32:35], s58 offen offset:512
    buffer_load_dwordx4 v[124:127], v2, s[32:35], s58 offen offset:512
    s_branch L_dft
L_mlp:
    s_add_u32 s60, s28, 12656640
    s_addc_u32 s61, s29, 0
    s_load_dword s47, s[60:61], 0
    s_lshl_b32 s46, s48, 4
    s_add_u32 s46, s46, s49
    s_lshl_b32 s46, s46, 8
    v_and_b32 v24, 31, v0
    v_lshrrev_b32 v25, 5, v0
    v_bfe_u32 v26, v0, 1, 3
    v_xor_b32 v26, v26, v25
    s_lshl_b32 s53, s51, 13
    v_lshlrev_b32 v27, 7, v24
    v_add_u32 v27, s53, v27
    v_xor_b32 v28, 0, v26
    v_lshl_add_u32 v10, v28, 4, v27
    v_xor_b32 v28, 2, v26
    v_lshl_add_u32 v11, v28, 4, v27
    v_xor_b32 v28, 4, v26
    v_lshl_add_u32 v12, v28, 4, v27
    v_xor_b32 v28, 6, v26
    v_lshl_add_u32 v13, v28, 4, v27
    v_bfe_u32 v26, v0, 2, 2
    v_lshl_add_u32 v27, v25, 3, v26
    v_lshlrev_b32 v27, 8, v27
    s_lshl_b32 s53, s50, 1
    s_add_u32 s53, s53, s51
    v_xor_b32 v26, s53, v26
    v_lshl_add_u32 v27, v26, 6, v27
    v_bfe_u32 v26, v0, 4, 1
    v_and_b32 v28, 3, v0
    v_lshlrev_b32 v30, 3, v28
    v_lshl_add_u32 v30, v26, 5, v30
    s_movk_i32 s59, 0x4000
    v_add3_u32 v18, v27, v30, s59
    v_xor_b32 v19, 64, v18
    v_bfe_u32 v27, v0, 2, 1
    v_xor_b32 v26, v26, v27
    v_or_b32 v26, v26, v28
    v_mov_b32 v27, 0x3f803f80
    v_cmp_eq_u32 vcc, 0, v26
    s_lshl_b32 s53, s53, 5
    v_add_u32 v26, s53, v24
    v_cndmask_b32 v172, 0, v27, vcc
    s_lshl_b32 s54, s49, 7
    v_add_lshl_u32 v56, v26, s54, 1
    v_xor_b32 v57, 64, v56
    s_mov_b32 s40, s18
    s_mov_b32 s41, s19
    s_mov_b32 s42, 3584
    s_mov_b32 s43, 0x20000
    buffer_load_ushort v56, v56, s[40:43], 0 offen
    buffer_load_ushort v57, v57, s[40:43], 0 offen
    s_lshl_b32 s53, s49, 2
    s_lshr_b32 s54, s48, 2
    s_add_u32 s53, s53, s54
    s_lshl_b32 s53, s53, 12
    s_add_u32 s53, s53, 1114112
    v_lshl_add_u32 v26, v26, 3, s53
    s_lshl_b32 s54, s100, 10
    v_add_u32 v16, s54, v26
    v_lshl_add_u32 v15, v25, 11, v26
    v_xor_b32 v17, 256, v15
    s_lshl_b32 s53, s63, 11
    s_lshl_b32 s54, s51, 10
    s_add_u32 s53, s53, s54
    s_add_u32 s53, s53, 1048576
    v_lshl_add_u32 v14, v24, 4, s53
    v_and_b32 v27, 1, v0
    v_lshlrev_b32 v27, 9, v27
    v_bfe_u32 v28, v0, 1, 4
    v_lshl_add_u32 v27, v28, 4, v27
    v_add_u32 v14, s53, v27
    s_add_u32 s40, s28, 12582912
    s_addc_u32 s41, s29, 0
    s_mov_b32 s42, 4194304
    s_mov_b32 s43, 0x20000
    v_add_u32 v200, 0x10000, v10
    v_add_u32 v201, 0x10000, v11
    v_add_u32 v202, 0x10000, v12
    v_add_u32 v203, 0x10000, v13
    v_add_u32 v204, 0x10000, v18
    v_add_u32 v205, 0x10000, v19
    s_cmp_eq_u32 s31, 9
    s_cselect_b32 s31, 1, s31
    s_cmp_eq_u32 s31, 18
    s_cselect_b32 s31, 2, s31
    s_cmp_eq_u32 s31, 27
    s_cselect_b32 s31, 3, s31
    s_and_b32 s70, s30, 1
    s_lshl_b32 s70, s70, 2
    s_lshr_b32 s0, s31, 2
    s_add_u32 s0, s0, s31
    s_and_b32 s0, s0, 3
    s_add_u32 s70, s70, s0
    s_lshr_b32 s45, s30, 1
    s_lshl_b32 s45, s45, 2
    s_lshr_b32 s0, s31, 3
    s_add_u32 s45, s45, s0
    s_bfe_u32 s1, s31, 0x10002
    s_sub_u32 s0, 32, s45
    s_cmp_eq_u32 s45, 0
    s_cselect_b32 s0, 16, s0
    s_cmp_eq_u32 s1, 0
    s_cselect_b32 s71, s45, s0
    s_lshr_b32 s44, s31, 2
    s_mul_i32 s44, s44, 7
    s_lshr_b32 s44, s44, 2
    s_lshl_b32 s68, s44, 15
    s_lshl_b32 s69, s3, 13
    v_lshrrev_b32 v180, 3, v0
    v_bfe_u32 v181, v0, 4, 1
    v_lshlrev_b32 v182, 2, v181
    v_and_b32 v183, 7, v0
    v_xor_b32 v182, v182, v183
    v_lshlrev_b32 v182, 4, v182
    v_lshl_add_u32 v182, v180, 10, v182
    s_mul_i32 s0, s3, 458752
    s_lshl_b32 s1, s70, 7
    s_add_u32 s0, s0, s1
    v_add_u32 v246, s0, v182
    v_add_u32 v247, 7168, v246
    v_add_u32 v248, 14336, v246
    v_add_u32 v249, 21504, v246
    s_mov_b32 s64, s20
    buffer_load_dwordx4 v8, s[36:39], s58 offen offset:2048 lds
    buffer_load_dwordx4 v9, s[36:39], s58 offen offset:3072 lds
    s_lshl_b32 s57, s56, 7
    s_mul_i32 s58, s56, 229376
    s_add_u32 m0, s55, 65536
    s_nop 0
    buffer_load_dwordx4 v2, s[32:35], s57 offen offset:0 lds
    buffer_load_dwordx4 v3, s[32:35], s57 offen offset:1024 lds
    buffer_load_dwordx4 v4, s[32:35], s57 offen offset:2048 lds
    buffer_load_dwordx4 v5, s[32:35], s57 offen offset:3072 lds
    s_add_u32 m0, s55, 81920
    s_add_u32 s56, s56, 1
    s_and_b32 s56, s56, 7
    buffer_load_dwordx4 v6, s[36:39], s58 offen offset:0 lds
    buffer_load_dwordx4 v7, s[36:39], s58 offen offset:1024 lds
    buffer_load_dwordx4 v8, s[36:39], s58 offen offset:2048 lds
    buffer_load_dwordx4 v9, s[36:39], s58 offen offset:3072 lds
    s_waitcnt lgkmcnt(0)
    s_mul_i32 s47, s47, 0x9e3779b1
    s_add_u32 s47, s47, 0x85ebca6b
    v_mov_b32 v168, v172
    v_mov_b32 v169, v172
    v_mov_b32 v170, v172
    v_mov_b32 v171, v172
    s_waitcnt vmcnt(18)
    s_barrier
    ds_read_b64_tr_b16 v[32:33], v18 offset:0
    ds_read_b64_tr_b16 v[34:35], v18 offset:1024
    ds_read_b128 v[40:43], v10 offset:0
    ds_read_b128 v[44:47], v10 offset:4096
    ds_read_b64_tr_b16 v[36:37], v19 offset:0
    ds_read_b64_tr_b16 v[38:39], v19 offset:1024
    s_waitcnt lgkmcnt(3)
    v_mfma_f32_32x32x16_bf16 v[64:79], v[32:35], v[40:43], 0
    ds_read_b64_tr_b16 v[128:129], v18 offset:4096
    ds_read_b64_tr_b16 v[130:131], v18 offset:5120
    ds_read_b128 v[136:139], v11 offset:0
    s_waitcnt lgkmcnt(5)
    v_mfma_f32_32x32x16_bf16 v[80:95], v[32:35], v[44:47], 0
    ds_read_b128 v[140:143], v11 offset:4096
    ds_read_b64_tr_b16 v[132:133], v19 offset:4096
    ds_read_b64_tr_b16 v[134:135], v19 offset:5120
    s_waitcnt lgkmcnt(6)
    v_mfma_f32_32x32x16_bf16 v[96:111], v[36:39], v[40:43], 0
    s_lshl_b32 s57, s56, 7
    s_mul_i32 s58, s56, 229376
    s_add_u32 m0, s55, 98304
    s_nop 0
    buffer_load_dwordx4 v2, s[32:35], s57 offen offset:0 lds
    s_mov_b32 s65, s21
    s_mov_b32 s66, 1835008
    v_mfma_f32_16x16x32_bf16 v[164:167], v[168:171], v[32:35], 0
    v_mfma_f32_32x32x16_bf16 v[112:127], v[36:39], v[44:47], 0
    buffer_load_dwordx4 v3, s[32:35], s57 offen offset:1024 lds
    s_mov_b32 s67, 0x20000
    s_mov_b32 s72, s22
    s_waitcnt lgkmcnt(3)
    v_mfma_f32_32x32x16_bf16 v[64:79], v[128:131], v[136:139], v[64:79]
    ds_read_b64_tr_b16 v[32:33], v18 offset:8192
    ds_read_b64_tr_b16 v[34:35], v18 offset:9216
    ds_read_b128 v[40:43], v12 offset:0
    s_waitcnt lgkmcnt(5)
    v_mfma_f32_32x32x16_bf16 v[80:95], v[128:131], v[140:143], v[80:95]
    ds_read_b128 v[44:47], v12 offset:4096
    ds_read_b64_tr_b16 v[36:37], v19 offset:8192
    ds_read_b64_tr_b16 v[38:39], v19 offset:9216
    s_waitcnt lgkmcnt(6)
    v_mfma_f32_32x32x16_bf16 v[96:111], v[132:135], v[136:139], v[96:111]
    buffer_load_dwordx4 v4, s[32:35], s57 offen offset:2048 lds
    s_mov_b32 s73, s23
    s_mov_b32 s74, 1024
    v_mfma_f32_16x16x32_bf16 v[164:167], v[168:171], v[128:131], v[164:167]
    v_mfma_f32_32x32x16_bf16 v[112:127], v[132:135], v[140:143], v[112:127]
    buffer_load_dwordx4 v5, s[32:35], s57 offen offset:3072 lds
    s_mov_b32 s75, 0x20000
    s_mov_b32 s76, s4
    s_waitcnt lgkmcnt(3)
    v_mfma_f32_32x32x16_bf16 v[64:79], v[32:35], v[40:43], v[64:79]
    ds_read_b64_tr_b16 v[128:129], v18 offset:12288
    ds_read_b64_tr_b16 v[130:131], v18 offset:13312
    ds_read_b128 v[136:139], v13 offset:0
    s_waitcnt lgkmcnt(5)
    v_mfma_f32_32x32x16_bf16 v[80:95], v[32:35], v[44:47], v[80:95]
    ds_read_b128 v[140:143], v13 offset:4096
    ds_read_b64_tr_b16 v[132:133], v19 offset:12288
    ds_read_b64_tr_b16 v[134:135], v19 offset:13312
    s_waitcnt lgkmcnt(6)
    v_mfma_f32_32x32x16_bf16 v[96:111], v[36:39], v[40:43], v[96:111]
    s_add_u32 m0, s55, 114688
    s_add_u32 s56, s56, 1
    s_and_b32 s56, s56, 7
    buffer_load_dwordx4 v6, s[36:39], s58 offen offset:0 lds
    s_mov_b32 s77, s5
    s_mov_b32 s78, 2097152
    v_mfma_f32_16x16x32_bf16 v[164:167], v[168:171], v[32:35], v[164:167]
    v_mfma_f32_32x32x16_bf16 v[112:127], v[36:39], v[44:47], v[112:127]
    buffer_load_dwordx4 v7, s[36:39], s58 offen offset:1024 lds
    s_mov_b32 s79, 0x20000
    v_lshrrev_b32 v180, 5, v0
    s_waitcnt lgkmcnt(0)
    v_mfma_f32_32x32x16_bf16 v[64:79], v[128:131], v[136:139], v[64:79]
    buffer_load_dwordx4 v8, s[36:39], s58 offen offset:2048 lds
    buffer_load_dwordx4 v9, s[36:39], s58 offen offset:3072 lds
    s_waitcnt vmcnt(16)
    s_barrier
    ds_read_b64_tr_b16 v[32:33], v18 offset:32768
    ds_read_b64_tr_b16 v[34:35], v18 offset:33792
    ds_read_b128 v[40:43], v10 offset:32768
    v_mfma_f32_32x32x16_bf16 v[80:95], v[128:131], v[140:143], v[80:95]
    ds_read_b128 v[44:47], v10 offset:36864
    ds_read_b64_tr_b16 v[36:37], v19 offset:32768
    ds_read_b64_tr_b16 v[38:39], v19 offset:33792
    v_mfma_f32_32x32x16_bf16 v[96:111], v[132:135], v[136:139], v[96:111]
    s_lshl_b32 s57, s56, 7
    s_mul_i32 s58, s56, 229376
    s_add_u32 m0, s55, 0
    s_nop 0
    buffer_load_dwordx4 v2, s[32:35], s57 offen offset:0 lds
    v_bfe_u32 v181, v0, 4, 1
    v_bfe_u32 v182, v0, 2, 2
    v_mfma_f32_16x16x32_bf16 v[164:167], v[168:171], v[128:131], v[164:167]
    v_mfma_f32_32x32x16_bf16 v[112:127], v[132:135], v[140:143], v[112:127]
    buffer_load_dwordx4 v3, s[32:35], s57 offen offset:1024 lds
    buffer_load_dwordx4 v4, s[32:35], s57 offen offset:2048 lds
    v_lshl_add_u32 v183, v180, 2, v182
    v_lshlrev_b32 v183, 7, v183
    s_waitcnt lgkmcnt(3)
    v_mfma_f32_32x32x16_bf16 v[64:79], v[32:35], v[40:43], v[64:79]
    ds_read_b64_tr_b16 v[128:129], v18 offset:36864
    ds_read_b64_tr_b16 v[130:131], v18 offset:37888
    ds_read_b128 v[136:139], v11 offset:32768
    s_waitcnt lgkmcnt(5)
    v_mfma_f32_32x32x16_bf16 v[80:95], v[32:35], v[44:47], v[80:95]
    ds_read_b128 v[140:143], v11 offset:36864
    ds_read_b64_tr_b16 v[132:133], v19 offset:36864
    ds_read_b64_tr_b16 v[134:135], v19 offset:37888
    s_waitcnt lgkmcnt(6)
    v_mfma_f32_32x32x16_bf16 v[96:111], v[36:39], v[40:43], v[96:111]
    buffer_load_dwordx4 v5, s[32:35], s57 offen offset:3072 lds
    v_lshrrev_b32 v182, 1, v182
    s_and_b32 s0, s3, 1
    v_mfma_f32_16x16x32_bf16 v[164:167], v[168:171], v[32:35], v[164:167]
    v_mfma_f32_32x32x16_bf16 v[112:127], v[36:39], v[44:47], v[112:127]
    s_add_u32 m0, s55, 16384
    s_add_u32 s56, s56, 1
    s_and_b32 s56, s56, 7
    buffer_load_dwordx4 v6, s[36:39], s58 offen offset:0 lds
    buffer_load_dwordx4 v7, s[36:39], s58 offen offset:1024 lds
    v_xor_b32 v182, s0, v182
    v_lshl_add_u32 v183, v182, 6, v183
    s_waitcnt lgkmcnt(3)
    v_mfma_f32_32x32x16_bf16 v[64:79], v[128:131], v[136:139], v[64:79]
    ds_read_b64_tr_b16 v[32:33], v18 offset:40960
    ds_read_b64_tr_b16 v[34:35], v18 offset:41984
    ds_read_b128 v[40:43], v12 offset:32768
    s_waitcnt lgkmcnt(5)
    v_mfma_f32_32x32x16_bf16 v[80:95], v[128:131], v[140:143], v[80:95]
    ds_read_b128 v[44:47], v12 offset:36864
    ds_read_b64_tr_b16 v[36:37], v19 offset:40960
    ds_read_b64_tr_b16 v[38:39], v19 offset:41984
    s_waitcnt lgkmcnt(6)
    v_mfma_f32_32x32x16_bf16 v[96:111], v[132:135], v[136:139], v[96:111]
    buffer_load_dwordx4 v8, s[36:39], s58 offen offset:2048 lds
    v_lshl_add_u32 v183, v181, 5, v183
    v_and_b32 v182, 3, v0
    v_mfma_f32_16x16x32_bf16 v[164:167], v[168:171], v[128:131], v[164:167]
    v_mfma_f32_32x32x16_bf16 v[112:127], v[132:135], v[140:143], v[112:127]
    buffer_load_dwordx4 v9, s[36:39], s58 offen offset:3072 lds
    v_lshl_add_u32 v183, v182, 3, v183
    v_add_u32 v250, s69, v183
    s_waitcnt lgkmcnt(3)
    v_mfma_f32_32x32x16_bf16 v[64:79], v[32:35], v[40:43], v[64:79]
    ds_read_b64_tr_b16 v[128:129], v18 offset:45056
    ds_read_b64_tr_b16 v[130:131], v18 offset:46080
    ds_read_b128 v[136:139], v13 offset:32768
    s_waitcnt lgkmcnt(5)
    v_mfma_f32_32x32x16_bf16 v[80:95], v[32:35], v[44:47], v[80:95]
    ds_read_b128 v[140:143], v13 offset:36864
    ds_read_b64_tr_b16 v[132:133], v19 offset:45056
    ds_read_b64_tr_b16 v[134:135], v19 offset:46080
    s_waitcnt lgkmcnt(6)
    v_mfma_f32_32x32x16_bf16 v[96:111], v[36:39], v[40:43], v[96:111]
    s_add_u32 m0, s69, 131072
    s_nop 0
    buffer_load_dwordx4 v246, s[64:67], s68 offen offset:0 lds
    v_xor_b32 v251, 64, v250
    v_add_u32 v252, 0x18000, v250
    v_mfma_f32_16x16x32_bf16 v[164:167], v[168:171], v[32:35], v[164:167]
    v_mfma_f32_32x32x16_bf16 v[112:127], v[36:39], v[44:47], v[112:127]
    buffer_load_dwordx4 v247, s[64:67], s68 offen offset:1024 lds
    v_add_u32 v253, 0x18000, v251
    s_and_b32 s0, s30, 1
    s_waitcnt lgkmcnt(0)
    v_mfma_f32_32x32x16_bf16 v[64:79], v[128:131], v[136:139], v[64:79]
    buffer_load_dwordx4 v248, s[64:67], s68 offen offset:2048 lds
    buffer_load_dwordx4 v249, s[64:67], s68 offen offset:3072 lds
    s_add_u32 s68, s68, 32768
    s_cmp_eq_u32 s68, 458752
    s_cselect_b32 s68, 0, s68
    s_waitcnt vmcnt(20)
    s_barrier
    ds_read_b64_tr_b16 v[32:33], v204 offset:0
    ds_read_b64_tr_b16 v[34:35], v204 offset:1024
    ds_read_b128 v[40:43], v200 offset:0
    v_mfma_f32_32x32x16_bf16 v[80:95], v[128:131], v[140:143], v[80:95]
    ds_read_b128 v[44:47], v200 offset:4096
    ds_read_b64_tr_b16 v[36:37], v205 offset:0
    ds_read_b64_tr_b16 v[38:39], v205 offset:1024
    v_mfma_f32_32x32x16_bf16 v[96:111], v[132:135], v[136:139], v[96:111]
    s_lshl_b32 s57, s56, 7
    s_mul_i32 s58, s56, 229376
    s_add_u32 m0, s55, 32768
    s_nop 0
    buffer_load_dwordx4 v2, s[32:35], s57 offen offset:0 lds
    s_lshl_b32 s0, s0, 9
    s_add_u32 s0, s0, 65536
    v_mfma_f32_16x16x32_bf16 v[164:167], v[168:171], v[128:131], v[164:167]
    v_mfma_f32_32x32x16_bf16 v[112:127], v[132:135], v[140:143], v[112:127]
    buffer_load_dwordx4 v3, s[32:35], s57 offen offset:1024 lds
    buffer_load_dwordx4 v4, s[32:35], s57 offen offset:2048 lds
    v_and_b32 v183, 31, v0
    v_lshl_add_u32 v62, v183, 2, s0
    s_waitcnt lgkmcnt(3)
    v_mfma_f32_32x32x16_bf16 v[64:79], v[32:35], v[40:43], v[64:79]
    ds_read_b64_tr_b16 v[128:129], v204 offset:4096
    ds_read_b64_tr_b16 v[130:131], v204 offset:5120
    ds_read_b128 v[136:139], v201 offset:0
    s_waitcnt lgkmcnt(5)
    v_mfma_f32_32x32x16_bf16 v[80:95], v[32:35], v[44:47], v[80:95]
    ds_read_b128 v[140:143], v201 offset:4096
    ds_read_b64_tr_b16 v[132:133], v205 offset:4096
    ds_read_b64_tr_b16 v[134:135], v205 offset:5120
    s_waitcnt lgkmcnt(6)
    v_mfma_f32_32x32x16_bf16 v[96:111], v[36:39], v[40:43], v[96:111]
    buffer_load_dwordx4 v5, s[32:35], s57 offen offset:3072 lds
    s_mul_i32 s0, s3, 7
    s_lshr_b32 s0, s0, 1
    v_mfma_f32_32x32x16_bf16 v[112:127], v[36:39], v[44:47], v[112:127]
    s_add_u32 m0, s55, 49152
    s_add_u32 s56, s56, 1
    s_and_b32 s56, s56, 7
    buffer_load_dwordx4 v6, s[36:39], s58 offen offset:0 lds
    buffer_load_dwordx4 v7, s[36:39], s58 offen offset:1024 lds
    s_lshl_b32 s1, s45, 4
    s_add_u32 s0, s0, s1
    s_waitcnt lgkmcnt(3)
    v_mfma_f32_32x32x16_bf16 v[64:79], v[128:131], v[136:139], v[64:79]
    ds_read_b64_tr_b16 v[32:33], v204 offset:8192
    ds_read_b64_tr_b16 v[34:35], v204 offset:9216
    ds_read_b128 v[40:43], v202 offset:0
    s_waitcnt lgkmcnt(5)
    v_mfma_f32_32x32x16_bf16 v[80:95], v[128:131], v[140:143], v[80:95]
    ds_read_b128 v[44:47], v202 offset:4096
    ds_read_b64_tr_b16 v[36:37], v205 offset:8192
    ds_read_b64_tr_b16 v[38:39], v205 offset:9216
    s_waitcnt lgkmcnt(6)
    v_mfma_f32_32x32x16_bf16 v[96:111], v[132:135], v[136:139], v[96:111]
    buffer_load_dwordx4 v8, s[36:39], s58 offen offset:2048 lds
    s_lshl_b32 s0, s0, 1
    s_and_b32 s1, s30, 1
    v_mfma_f32_32x32x16_bf16 v[112:127], v[132:135], v[140:143], v[112:127]
    buffer_load_dwordx4 v9, s[36:39], s58 offen offset:3072 lds
    v_mov_b32 v165, s47
    buffer_store_dwordx2 v[164:165], v16, s[40:43], 0 offen sc1
    s_add_u32 s0, s0, s1
    s_lshl_b32 s0, s0, 7
    s_waitcnt lgkmcnt(3)
    v_mfma_f32_32x32x16_bf16 v[64:79], v[32:35], v[40:43], v[64:79]
    ds_read_b64_tr_b16 v[128:129], v204 offset:12288
    ds_read_b64_tr_b16 v[130:131], v204 offset:13312
    ds_read_b128 v[136:139], v203 offset:0
    s_waitcnt lgkmcnt(5)
    v_mfma_f32_32x32x16_bf16 v[80:95], v[32:35], v[44:47], v[80:95]
    ds_read_b128 v[140:143], v203 offset:4096
    ds_read_b64_tr_b16 v[132:133], v205 offset:12288
    ds_read_b64_tr_b16 v[134:135], v205 offset:13312
    s_waitcnt lgkmcnt(6)
    v_mfma_f32_32x32x16_bf16 v[96:111], v[36:39], v[40:43], v[96:111]
    s_add_u32 m0, s69, 135168
    s_nop 0
    buffer_load_dwordx4 v246, s[64:67], s68 offen offset:0 lds
    v_bfe_u32 v182, v0, 2, 2
    v_lshl_add_u32 v63, v182, 8, s0
    v_mfma_f32_32x32x16_bf16 v[112:127], v[36:39], v[44:47], v[112:127]
    buffer_load_dwordx4 v247, s[64:67], s68 offen offset:1024 lds
    s_lshr_b32 s1, s3, 1
    s_lshl_b32 s0, s1, 10
    s_waitcnt lgkmcnt(0)
    v_mfma_f32_32x32x16_bf16 v[64:79], v[128:131], v[136:139], v[64:79]
    buffer_load_dwordx4 v248, s[64:67], s68 offen offset:2048 lds
    buffer_load_dwordx4 v249, s[64:67], s68 offen offset:3072 lds
    s_add_u32 s68, s68, 32768
    s_cmp_eq_u32 s68, 458752
    s_cselect_b32 s68, 0, s68
    s_waitcnt vmcnt(25)
    s_barrier
    ds_read_b64_tr_b16 v[32:33], v204 offset:32768
    ds_read_b64_tr_b16 v[34:35], v204 offset:33792
    ds_read_b128 v[40:43], v200 offset:32768
    v_mfma_f32_32x32x16_bf16 v[80:95], v[128:131], v[140:143], v[80:95]
    ds_read_b128 v[44:47], v200 offset:36864
    ds_read_b64_tr_b16 v[36:37], v205 offset:32768
    ds_read_b64_tr_b16 v[38:39], v205 offset:33792
    v_mfma_f32_32x32x16_bf16 v[96:111], v[132:135], v[136:139], v[96:111]
    s_lshl_b32 s57, s56, 7
    s_mul_i32 s58, s56, 229376
    s_add_u32 m0, s55, 65536
    s_nop 0
    buffer_load_dwordx4 v2, s[32:35], s57 offen offset:0 lds
    v_lshl_add_u32 v59, v0, 4, s0
    v_xor_b32 v60, 0x400, v59
    v_mfma_f32_32x32x16_bf16 v[112:127], v[132:135], v[140:143], v[112:127]
    buffer_load_dwordx4 v3, s[32:35], s57 offen offset:1024 lds
    buffer_load_dwordx4 v4, s[32:35], s57 offen offset:2048 lds
    s_lshl_b32 s0, s1, 5
    v_and_b32 v182, 31, v0
    s_waitcnt lgkmcnt(3)
    v_mfma_f32_32x32x16_bf16 v[64:79], v[32:35], v[40:43], v[64:79]
    ds_read_b64_tr_b16 v[128:129], v204 offset:36864
    ds_read_b64_tr_b16 v[130:131], v204 offset:37888
    ds_read_b128 v[136:139], v201 offset:32768
    s_waitcnt lgkmcnt(5)
    v_mfma_f32_32x32x16_bf16 v[80:95], v[32:35], v[44:47], v[80:95]
    ds_read_b128 v[140:143], v201 offset:36864
    ds_read_b64_tr_b16 v[132:133], v205 offset:36864
    ds_read_b64_tr_b16 v[134:135], v205 offset:37888
    s_waitcnt lgkmcnt(6)
    v_mfma_f32_32x32x16_bf16 v[96:111], v[36:39], v[40:43], v[96:111]
    buffer_load_dwordx4 v5, s[32:35], s57 offen offset:3072 lds
    v_add_u32 v181, s0, v182
    v_lshlrev_b32 v181, 5, v181
    v_mfma_f32_32x32x16_bf16 v[112:127], v[36:39], v[44:47], v[112:127]
    s_add_u32 m0, s55, 81920
    s_add_u32 s56, s56, 1
    s_and_b32 s56, s56, 7
    buffer_load_dwordx4 v6, s[36:39], s58 offen offset:0 lds
    v_add_u32 v245, s71, v181
    s_lshl_b32 s0, s0, 15
    s_waitcnt lgkmcnt(3)
    v_mfma_f32_32x32x16_bf16 v[64:79], v[128:131], v[136:139], v[64:79]
    ds_read_b64_tr_b16 v[32:33], v204 offset:40960
    ds_read_b64_tr_b16 v[34:35], v204 offset:41984
    ds_read_b128 v[40:43], v202 offset:32768
    s_waitcnt lgkmcnt(5)
    v_mfma_f32_32x32x16_bf16 v[80:95], v[128:131], v[140:143], v[80:95]
    ds_read_b128 v[44:47], v202 offset:36864
    ds_read_b64_tr_b16 v[36:37], v205 offset:40960
    ds_read_b64_tr_b16 v[38:39], v205 offset:41984
    s_waitcnt lgkmcnt(6)
    v_mfma_f32_32x32x16_bf16 v[96:111], v[132:135], v[136:139], v[96:111]
    buffer_load_dwordx4 v7, s[36:39], s58 offen offset:1024 lds
    s_lshl_b32 s1, s71, 10
    s_add_u32 s1, s1, s0
    v_mfma_f32_32x32x16_bf16 v[112:127], v[132:135], v[140:143], v[112:127]
    buffer_load_dwordx4 v8, s[36:39], s58 offen offset:2048 lds
    v_lshrrev_b32 v181, 2, v0
    v_lshlrev_b32 v181, 15, v181
    s_waitcnt lgkmcnt(3)
    v_mfma_f32_32x32x16_bf16 v[64:79], v[32:35], v[40:43], v[64:79]
    ds_read_b64_tr_b16 v[128:129], v204 offset:45056
    ds_read_b64_tr_b16 v[130:131], v204 offset:46080
    ds_read_b128 v[136:139], v203 offset:32768
    s_waitcnt lgkmcnt(5)
    v_mfma_f32_32x32x16_bf16 v[80:95], v[32:35], v[44:47], v[80:95]
    ds_read_b128 v[140:143], v203 offset:36864
    ds_read_b64_tr_b16 v[132:133], v205 offset:45056
    ds_read_b64_tr_b16 v[134:135], v205 offset:46080
    s_waitcnt lgkmcnt(6)
    v_mfma_f32_32x32x16_bf16 v[96:111], v[36:39], v[40:43], v[96:111]
    buffer_load_dwordx4 v9, s[36:39], s58 offen offset:3072 lds
    v_lshrrev_b32 v183, 4, v0
    v_xor_b32 v183, v183, v0
    v_mfma_f32_32x32x16_bf16 v[112:127], v[36:39], v[44:47], v[112:127]
    v_and_b32 v183, 3, v183
    v_lshl_add_u32 v181, v183, 4, v181
    v_add_u32 v181, s1, v181
    s_lshl_b32 s0, s70, 7
    s_and_b32 s1, s3, 1
    s_waitcnt lgkmcnt(0)
    v_mfma_f32_32x32x16_bf16 v[64:79], v[128:131], v[136:139], v[64:79]
    s_waitcnt vmcnt(25)
    s_barrier
    ds_read_b64_tr_b16 v[32:33], v18 offset:0
    ds_read_b64_tr_b16 v[34:35], v18 offset:1024
    ds_read_b128 v[40:43], v10 offset:0
    v_mfma_f32_32x32x16_bf16 v[80:95], v[128:131], v[140:143], v[80:95]
    ds_read_b128 v[44:47], v10 offset:4096
    ds_read_b64_tr_b16 v[36:37], v19 offset:0
    ds_read_b64_tr_b16 v[38:39], v19 offset:1024
    v_mfma_f32_32x32x16_bf16 v[96:111], v[132:135], v[136:139], v[96:111]
    s_lshl_b32 s57, s56, 7
    s_mul_i32 s58, s56, 229376
    s_add_u32 m0, s55, 98304
    s_nop 0
    buffer_load_dwordx4 v2, s[32:35], s57 offen offset:0 lds
    s_lshl_b32 s1, s1, 6
    s_add_u32 s0, s0, s1
    v_mfma_f32_32x32x16_bf16 v[112:127], v[132:135], v[140:143], v[112:127]
    buffer_load_dwordx4 v3, s[32:35], s57 offen offset:1024 lds
    buffer_load_dwordx4 v4, s[32:35], s57 offen offset:2048 lds
    v_add_u32 v255, s0, v181
    v_lshl_add_u32 v254, v182, 1, s0
    s_waitcnt lgkmcnt(3)
    v_mfma_f32_32x32x16_bf16 v[64:79], v[32:35], v[40:43], v[64:79]
    ds_read_b64_tr_b16 v[128:129], v18 offset:4096
    ds_read_b64_tr_b16 v[130:131], v18 offset:5120
    ds_read_b128 v[136:139], v11 offset:0
    s_waitcnt lgkmcnt(5)
    v_mfma_f32_32x32x16_bf16 v[80:95], v[32:35], v[44:47], v[80:95]
    ds_read_b128 v[140:143], v11 offset:4096
    ds_read_b64_tr_b16 v[132:133], v19 offset:4096
    ds_read_b64_tr_b16 v[134:135], v19 offset:5120
    s_waitcnt lgkmcnt(6)
    v_mfma_f32_32x32x16_bf16 v[96:111], v[36:39], v[40:43], v[96:111]
    buffer_load_dwordx4 v5, s[32:35], s57 offen offset:3072 lds
    s_lshr_b32 s0, s0, 1
    v_and_b32 v181, 20, v0
    v_mfma_f32_32x32x16_bf16 v[112:127], v[36:39], v[44:47], v[112:127]
    s_add_u32 m0, s55, 114688
    s_add_u32 s56, s56, 1
    s_and_b32 s56, s56, 7
    buffer_load_dwordx4 v6, s[36:39], s58 offen offset:0 lds
    v_bfe_u32 v183, v0, 1, 1
    v_lshl_add_u32 v181, v183, 3, v181
    s_waitcnt lgkmcnt(3)
    v_mfma_f32_32x32x16_bf16 v[64:79], v[128:131], v[136:139], v[64:79]
    ds_read_b64_tr_b16 v[32:33], v18 offset:8192
    ds_read_b64_tr_b16 v[34:35], v18 offset:9216
    ds_read_b128 v[40:43], v12 offset:0
    s_waitcnt lgkmcnt(5)
    v_mfma_f32_32x32x16_bf16 v[80:95], v[128:131], v[140:143], v[80:95]
    ds_read_b128 v[44:47], v12 offset:4096
    ds_read_b64_tr_b16 v[36:37], v19 offset:8192
    ds_read_b64_tr_b16 v[38:39], v19 offset:9216
    s_waitcnt lgkmcnt(6)
    v_mfma_f32_32x32x16_bf16 v[96:111], v[132:135], v[136:139], v[96:111]
    buffer_load_dwordx4 v7, s[36:39], s58 offen offset:1024 lds
    v_and_b32 v183, 1, v0
    v_lshl_add_u32 v181, v183, 1, v181
    v_mfma_f32_32x32x16_bf16 v[112:127], v[132:135], v[140:143], v[112:127]
    buffer_load_dwordx4 v8, s[36:39], s58 offen offset:2048 lds
    v_bfe_u32 v183, v0, 3, 1
    v_add3_u32 v182, v181, v183, s0
    s_waitcnt lgkmcnt(3)
    v_mfma_f32_32x32x16_bf16 v[64:79], v[32:35], v[40:43], v[64:79]
    ds_read_b64_tr_b16 v[128:129], v18 offset:12288
    ds_read_b64_tr_b16 v[130:131], v18 offset:13312
    ds_read_b128 v[136:139], v13 offset:0
    s_waitcnt lgkmcnt(5)
    v_mfma_f32_32x32x16_bf16 v[80:95], v[32:35], v[44:47], v[80:95]
    ds_read_b128 v[140:143], v13 offset:4096
    ds_read_b64_tr_b16 v[132:133], v19 offset:12288
    ds_read_b64_tr_b16 v[134:135], v19 offset:13312
    s_waitcnt lgkmcnt(6)
    v_mfma_f32_32x32x16_bf16 v[96:111], v[36:39], v[40:43], v[96:111]
    buffer_load_dwordx4 v9, s[36:39], s58 offen offset:3072 lds
    s_cmp_lt_u32 s70, 4
    s_cselect_b32 s0, 0, -1
    s_cselect_b32 s1, 0, 513
    v_mfma_f32_32x32x16_bf16 v[112:127], v[36:39], v[44:47], v[112:127]
    v_xor_b32 v183, s0, v182
    v_add_u32 v183, s1, v183
    v_and_b32 v184, 1, v183
    v_lshlrev_b32 v184, 11, v184
    v_bfe_u32 v183, v183, 1, 7
    s_waitcnt lgkmcnt(0)
    v_mfma_f32_32x32x16_bf16 v[64:79], v[128:131], v[136:139], v[64:79]
    s_waitcnt vmcnt(21)
    s_barrier
    ds_read_b64_tr_b16 v[32:33], v18 offset:32768
    ds_read_b64_tr_b16 v[34:35], v18 offset:33792
    ds_read_b128 v[40:43], v10 offset:32768
    v_mfma_f32_32x32x16_bf16 v[80:95], v[128:131], v[140:143], v[80:95]
    ds_read_b128 v[44:47], v10 offset:36864
    ds_read_b64_tr_b16 v[36:37], v19 offset:32768
    ds_read_b64_tr_b16 v[38:39], v19 offset:33792
    v_mfma_f32_32x32x16_bf16 v[96:111], v[132:135], v[136:139], v[96:111]
    s_add_u32 m0, s69, 0
    s_nop 0
    buffer_load_dwordx4 v246, s[64:67], s68 offen offset:0 lds
    v_lshl_add_u32 v183, v183, 4, v184
    v_lshl_add_u32 v183, v180, 12, v183
    v_mfma_f32_32x32x16_bf16 v[112:127], v[132:135], v[140:143], v[112:127]
    buffer_load_dwordx4 v247, s[64:67], s68 offen offset:1024 lds
    buffer_load_dwordx4 v248, s[64:67], s68 offen offset:2048 lds
    s_mul_i32 s0, s71, 65520
    s_sub_u32 s0, 0x200000, s0
    s_waitcnt lgkmcnt(3)
    v_mfma_f32_32x32x16_bf16 v[64:79], v[32:35], v[40:43], v[64:79]
    ds_read_b64_tr_b16 v[128:129], v18 offset:36864
    ds_read_b64_tr_b16 v[130:131], v18 offset:37888
    ds_read_b128 v[136:139], v11 offset:32768
    ds_read_b64_tr_b16 a[0:1], v252 offset:32768
    ds_read_b64_tr_b16 a[2:3], v252 offset:33792
    s_waitcnt lgkmcnt(7)
    v_mfma_f32_32x32x16_bf16 v[80:95], v[32:35], v[44:47], v[80:95]
    ds_read_b128 v[140:143], v11 offset:36864
    ds_read_b64_tr_b16 v[132:133], v19 offset:36864
    ds_read_b64_tr_b16 v[134:135], v19 offset:37888
    ds_read_b64_tr_b16 a[4:5], v253 offset:32768
    ds_read_b64_tr_b16 a[6:7], v253 offset:33792
    s_waitcnt lgkmcnt(10)
    v_mfma_f32_32x32x16_bf16 v[96:111], v[36:39], v[40:43], v[96:111]
    buffer_load_dwordx4 v249, s[64:67], s68 offen offset:3072 lds
    s_add_u32 s68, s68, 32768
    s_cmp_eq_u32 s68, 458752
    s_cselect_b32 s68, 0, s68
    v_add_u32 v184, s0, v183
    v_cmp_eq_u32 vcc, 0, v182
    v_mfma_f32_32x32x16_bf16 v[112:127], v[36:39], v[44:47], v[112:127]
    s_add_u32 m0, s69, 4096
    s_nop 0
    buffer_load_dwordx4 v246, s[64:67], s68 offen offset:0 lds
    s_nop 0
    v_cndmask_b32 v61, v183, v184, vcc
    s_waitcnt lgkmcnt(7)
    v_mfma_f32_32x32x16_bf16 v[64:79], v[128:131], v[136:139], v[64:79]
    ds_read_b64_tr_b16 v[32:33], v18 offset:40960
    ds_read_b64_tr_b16 v[34:35], v18 offset:41984
    ds_read_b128 v[40:43], v12 offset:32768
    ds_read_b64_tr_b16 a[8:9], v252 offset:34816
    ds_read_b64_tr_b16 a[10:11], v252 offset:35840
    s_waitcnt lgkmcnt(9)
    v_mfma_f32_32x32x16_bf16 v[80:95], v[128:131], v[140:143], v[80:95]
    ds_read_b128 v[44:47], v12 offset:36864
    ds_read_b64_tr_b16 v[36:37], v19 offset:40960
    ds_read_b64_tr_b16 v[38:39], v19 offset:41984
    ds_read_b64_tr_b16 a[12:13], v253 offset:34816
    ds_read_b64_tr_b16 a[14:15], v253 offset:35840
    s_waitcnt lgkmcnt(12)
    v_mfma_f32_32x32x16_bf16 v[96:111], v[132:135], v[136:139], v[96:111]
    buffer_load_dwordx4 v247, s[64:67], s68 offen offset:1024 lds
    v_mov_b32 v184, 0x40000000
    s_cmp_eq_u32 s3, 0
    s_cselect_b32 s0, s46, 0x40000000
    v_mfma_f32_32x32x16_bf16 v[112:127], v[132:135], v[140:143], v[112:127]
    buffer_load_dwordx4 v248, s[64:67], s68 offen offset:2048 lds
    v_cmp_gt_u32 vcc, 16, v0
    v_lshl_add_u32 v186, v0, 4, s0
    s_waitcnt lgkmcnt(7)
    v_mfma_f32_32x32x16_bf16 v[64:79], v[32:35], v[40:43], v[64:79]
    s_waitcnt vmcnt(23)
    ds_read_b64_tr_b16 v[128:129], v18 offset:45056
    ds_read_b64_tr_b16 v[130:131], v18 offset:46080
    ds_read_b128 v[136:139], v13 offset:32768
    ds_read_b64_tr_b16 a[16:17], v252 offset:36864
    ds_read_b64_tr_b16 a[18:19], v252 offset:37888
    s_waitcnt lgkmcnt(9)
    v_mfma_f32_32x32x16_bf16 v[80:95], v[32:35], v[44:47], v[80:95]
    ds_read_b128 v[140:143], v13 offset:36864
    ds_read_b64_tr_b16 v[132:133], v19 offset:45056
    ds_read_b64_tr_b16 v[134:135], v19 offset:46080
    ds_read_b64_tr_b16 a[20:21], v253 offset:36864
    ds_read_b64_tr_b16 a[22:23], v253 offset:37888
    s_waitcnt lgkmcnt(12)
    v_mfma_f32_32x32x16_bf16 v[96:111], v[36:39], v[40:43], v[96:111]
    buffer_load_dwordx4 v249, s[64:67], s68 offen offset:3072 lds
    s_add_u32 s68, s68, 32768
    s_cmp_eq_u32 s68, 458752
    s_cselect_b32 s68, 0, s68
    s_nop 0
    v_cndmask_b32 v58, v184, v186, vcc
    v_mfma_f32_32x32x16_bf16 v[112:127], v[36:39], v[44:47], v[112:127]
    s_waitcnt lgkmcnt(2)
    v_mfma_f32_32x32x16_bf16 v[64:79], v[128:131], v[136:139], v[64:79]
    s_waitcnt vmcnt(16)
    s_barrier
    ds_read_b64_tr_b16 v[32:33], v204 offset:0
    ds_read_b64_tr_b16 v[34:35], v204 offset:1024
    ds_read_b128 v[40:43], v200 offset:0
    ds_read_b64_tr_b16 a[24:25], v252 offset:38912
    ds_read_b64_tr_b16 a[26:27], v252 offset:39936
    v_mfma_f32_32x32x16_bf16 v[80:95], v[128:131], v[140:143], v[80:95]
    ds_read_b128 v[44:47], v200 offset:4096
    ds_read_b64_tr_b16 v[36:37], v205 offset:0
    ds_read_b64_tr_b16 v[38:39], v205 offset:1024
    ds_read_b64_tr_b16 a[28:29], v253 offset:38912
    ds_read_b64_tr_b16 a[30:31], v253 offset:39936
    v_mfma_f32_32x32x16_bf16 v[96:111], v[132:135], v[136:139], v[96:111]
    s_add_u32 m0, s69, 32768
    s_nop 0
    buffer_load_dwordx4 v246, s[64:67], s68 offen offset:0 lds
    s_mov_b32 s36, s28
    s_mov_b32 s37, s29
    v_mfma_f32_32x32x16_bf16 v[112:127], v[132:135], v[140:143], v[112:127]
    buffer_load_dwordx4 v247, s[64:67], s68 offen offset:1024 lds
    buffer_load_dwordx4 v248, s[64:67], s68 offen offset:2048 lds
    s_mov_b32 s38, 7340032
    s_mov_b32 s39, 0x20000
    s_waitcnt lgkmcnt(7)
    v_mfma_f32_32x32x16_bf16 v[64:79], v[32:35], v[40:43], v[64:79]
    ds_read_b64_tr_b16 v[128:129], v204 offset:4096
    ds_read_b64_tr_b16 v[130:131], v204 offset:5120
    ds_read_b128 v[136:139], v201 offset:0
    s_waitcnt lgkmcnt(7)
    v_mfma_f32_32x32x16_bf16 v[80:95], v[32:35], v[44:47], v[80:95]
    ds_read_b128 v[140:143], v201 offset:4096
    ds_read_b64_tr_b16 v[132:133], v205 offset:4096
    ds_read_b64_tr_b16 v[134:135], v205 offset:5120
    s_waitcnt lgkmcnt(8)
    v_mfma_f32_32x32x16_bf16 v[96:111], v[36:39], v[40:43], v[96:111]
    buffer_load_dwordx4 v249, s[64:67], s68 offen offset:3072 lds
    s_add_u32 s68, s68, 32768
    s_cmp_eq_u32 s68, 458752
    s_cselect_b32 s68, 0, s68
    s_mul_i32 s53, s52, 112
    s_lshl_b32 s54, s49, 3
    v_mfma_f32_32x32x16_bf16 v[112:127], v[36:39], v[44:47], v[112:127]
    s_add_u32 m0, s69, 36864
    s_nop 0
    buffer_load_dwordx4 v246, s[64:67], s68 offen offset:0 lds
    buffer_load_dwordx4 v247, s[64:67], s68 offen offset:1024 lds
    s_add_u32 s53, s53, s54
    s_lshl_b32 s54, s50, 2
    s_waitcnt lgkmcnt(3)
    v_mfma_f32_32x32x16_bf16 v[64:79], v[128:131], v[136:139], v[64:79]
    ds_read_b64_tr_b16 v[32:33], v204 offset:8192
    ds_read_b64_tr_b16 v[34:35], v204 offset:9216
    ds_read_b128 v[40:43], v202 offset:0
    s_waitcnt lgkmcnt(5)
    v_mfma_f32_32x32x16_bf16 v[80:95], v[128:131], v[140:143], v[80:95]
    ds_read_b128 v[44:47], v202 offset:4096
    ds_read_b64_tr_b16 v[36:37], v205 offset:8192
    ds_read_b64_tr_b16 v[38:39], v205 offset:9216
    s_waitcnt lgkmcnt(6)
    v_mfma_f32_32x32x16_bf16 v[96:111], v[132:135], v[136:139], v[96:111]
    buffer_load_dwordx4 v248, s[64:67], s68 offen offset:2048 lds
    s_add_u32 s53, s53, s54
    s_lshl_b32 s53, s53, 11
    v_mfma_f32_32x32x16_bf16 v[112:127], v[132:135], v[140:143], v[112:127]
    buffer_load_dwordx4 v249, s[64:67], s68 offen offset:3072 lds
    s_add_u32 s68, s68, 32768
    s_cmp_eq_u32 s68, 458752
    s_cselect_b32 s68, 0, s68
    buffer_load_dwordx4 v[144:147], v14, s[40:43], 0 offen offset:0 sc1
    s_lshl_b32 s54, s51, 12
    s_add_u32 s60, s53, s54
    s_waitcnt lgkmcnt(3)
    v_mfma_f32_32x32x16_bf16 v[64:79], v[32:35], v[40:43], v[64:79]
    s_waitcnt vmcnt(13)
    ds_read_b64_tr_b16 v[128:129], v204 offset:12288
    ds_read_b64_tr_b16 v[130:131], v204 offset:13312
    ds_read_b128 v[136:139], v203 offset:0
    ds_read_b64_tr_b16 a[32:33], v250 offset:0
    ds_read_b64_tr_b16 a[34:35], v250 offset:1024
    s_waitcnt lgkmcnt(7)
    v_mfma_f32_32x32x16_bf16 v[80:95], v[32:35], v[44:47], v[80:95]
    ds_read_b128 v[140:143], v203 offset:4096
    ds_read_b64_tr_b16 v[132:133], v205 offset:12288
    ds_read_b64_tr_b16 v[134:135], v205 offset:13312
    ds_read_b64_tr_b16 a[36:37], v251 offset:0
    ds_read_b64_tr_b16 a[38:39], v251 offset:1024
    s_waitcnt lgkmcnt(10)
    v_mfma_f32_32x32x16_bf16 v[96:111], v[36:39], v[40:43], v[96:111]
    buffer_load_dwordx4 v[148:151], v14, s[40:43], 0 offen offset:256 sc1
    s_xor_b32 s61, s60, 0x400
    s_xor_b32 s62, s60, 0x1000
    v_mfma_f32_32x32x16_bf16 v[112:127], v[36:39], v[44:47], v[112:127]
    buffer_load_dwordx2 v[152:153], v15, s[40:43], 0 offen offset:0 sc1
    buffer_load_dwordx2 v[154:155], v15, s[40:43], 0 offen offset:1024 sc1
    s_xor_b32 s63, s60, 0x1400
    s_waitcnt lgkmcnt(2)
    v_mfma_f32_32x32x16_bf16 v[64:79], v[128:131], v[136:139], v[64:79]
    buffer_load_dwordx2 v[156:157], v17, s[40:43], 0 offen offset:0 sc1
    buffer_load_dwordx2 v[158:159], v17, s[40:43], 0 offen offset:1024 sc1
    s_barrier
    ds_read_b64_tr_b16 v[32:33], v204 offset:32768
    ds_read_b64_tr_b16 v[34:35], v204 offset:33792
    ds_read_b128 v[40:43], v200 offset:32768
    ds_read_b64_tr_b16 a[40:41], v250 offset:2048
    ds_read_b64_tr_b16 a[42:43], v250 offset:3072
    v_mfma_f32_32x32x16_bf16 v[80:95], v[128:131], v[140:143], v[80:95]
    ds_read_b128 v[44:47], v200 offset:36864
    ds_read_b64_tr_b16 v[36:37], v205 offset:32768
    ds_read_b64_tr_b16 v[38:39], v205 offset:33792
    ds_read_b64_tr_b16 a[44:45], v251 offset:2048
    ds_read_b64_tr_b16 a[46:47], v251 offset:3072
    v_mfma_f32_32x32x16_bf16 v[96:111], v[132:135], v[136:139], v[96:111]
    s_add_u32 m0, s69, 65536
    s_nop 0
    buffer_load_dwordx4 v246, s[64:67], s68 offen offset:0 lds
    v_mfma_f32_32x32x16_bf16 v[112:127], v[132:135], v[140:143], v[112:127]
    buffer_load_dwordx4 v247, s[64:67], s68 offen offset:1024 lds
    buffer_load_dwordx4 v248, s[64:67], s68 offen offset:2048 lds
    s_waitcnt lgkmcnt(7)
    v_mfma_f32_32x32x16_bf16 v[64:79], v[32:35], v[40:43], v[64:79]
    s_waitcnt vmcnt(17)
    ds_read_b64_tr_b16 v[128:129], v204 offset:36864
    ds_read_b64_tr_b16 v[130:131], v204 offset:37888
    ds_read_b128 v[136:139], v201 offset:32768
    ds_read_b64_tr_b16 a[48:49], v250 offset:4096
    ds_read_b64_tr_b16 a[50:51], v250 offset:5120
    s_waitcnt lgkmcnt(9)
    v_mfma_f32_32x32x16_bf16 v[80:95], v[32:35], v[44:47], v[80:95]
    ds_read_b128 v[140:143], v201 offset:36864
    ds_read_b64_tr_b16 v[132:133], v205 offset:36864
    ds_read_b64_tr_b16 v[134:135], v205 offset:37888
    ds_read_b64_tr_b16 a[52:53], v251 offset:4096
    ds_read_b64_tr_b16 a[54:55], v251 offset:5120
    s_waitcnt lgkmcnt(12)
    v_mfma_f32_32x32x16_bf16 v[96:111], v[36:39], v[40:43], v[96:111]
    buffer_load_dwordx4 v249, s[64:67], s68 offen offset:3072 lds
    s_add_u32 s68, s68, 32768
    s_cmp_eq_u32 s68, 458752
    s_cselect_b32 s68, 0, s68
    v_mfma_f32_32x32x16_bf16 v[112:127], v[36:39], v[44:47], v[112:127]
    s_add_u32 m0, s69, 69632
    s_nop 0
    buffer_load_dwordx4 v246, s[64:67], s68 offen offset:0 lds
    s_waitcnt lgkmcnt(7)
    v_mfma_f32_32x32x16_bf16 v[64:79], v[128:131], v[136:139], v[64:79]
    ds_read_b64_tr_b16 v[32:33], v204 offset:40960
    ds_read_b64_tr_b16 v[34:35], v204 offset:41984
    ds_read_b128 v[40:43], v202 offset:32768
    ds_read_b64_tr_b16 a[56:57], v250 offset:6144
    ds_read_b64_tr_b16 a[58:59], v250 offset:7168
    s_waitcnt lgkmcnt(9)
    v_mfma_f32_32x32x16_bf16 v[80:95], v[128:131], v[140:143], v[80:95]
    ds_read_b128 v[44:47], v202 offset:36864
    ds_read_b64_tr_b16 v[36:37], v205 offset:40960
    ds_read_b64_tr_b16 v[38:39], v205 offset:41984
    ds_read_b64_tr_b16 a[60:61], v251 offset:6144
    ds_read_b64_tr_b16 a[62:63], v251 offset:7168
    s_waitcnt lgkmcnt(12)
    v_mfma_f32_32x32x16_bf16 v[96:111], v[132:135], v[136:139], v[96:111]
    buffer_load_dwordx4 v247, s[64:67], s68 offen offset:1024 lds
    v_mfma_f32_32x32x16_bf16 v[112:127], v[132:135], v[140:143], v[112:127]
    buffer_load_dwordx4 v248, s[64:67], s68 offen offset:2048 lds
    s_waitcnt lgkmcnt(7)
    v_mfma_f32_32x32x16_bf16 v[64:79], v[32:35], v[40:43], v[64:79]
    s_waitcnt vmcnt(17)
    ds_read_b64_tr_b16 v[128:129], v204 offset:45056
    ds_read_b64_tr_b16 v[130:131], v204 offset:46080
    ds_read_b128 v[136:139], v203 offset:32768
    ds_read_b64_tr_b16 a[64:65], v250 offset:32768
    ds_read_b64_tr_b16 a[66:67], v250 offset:33792
    s_waitcnt lgkmcnt(9)
    v_mfma_f32_32x32x16_bf16 v[80:95], v[32:35], v[44:47], v[80:95]
    ds_read_b128 v[140:143], v203 offset:36864
    ds_read_b64_tr_b16 v[132:133], v205 offset:45056
    ds_read_b64_tr_b16 v[134:135], v205 offset:46080
    ds_read_b64_tr_b16 a[68:69], v251 offset:32768
    ds_read_b64_tr_b16 a[70:71], v251 offset:33792
    s_waitcnt lgkmcnt(12)
    v_mfma_f32_32x32x16_bf16 v[96:111], v[36:39], v[40:43], v[96:111]
    buffer_load_dwordx4 v249, s[64:67], s68 offen offset:3072 lds
    s_add_u32 s68, s68, 32768
    s_cmp_eq_u32 s68, 458752
    s_cselect_b32 s68, 0, s68
    v_mfma_f32_32x32x16_bf16 v[112:127], v[36:39], v[44:47], v[112:127]
    s_waitcnt lgkmcnt(2)
    v_mfma_f32_32x32x16_bf16 v[64:79], v[128:131], v[136:139], v[64:79]
    s_barrier
    ds_read_b64_tr_b16 a[72:73], v250 offset:34816
    ds_read_b64_tr_b16 a[74:75], v250 offset:35840
    v_mfma_f32_32x32x16_bf16 v[80:95], v[128:131], v[140:143], v[80:95]
    ds_read_b64_tr_b16 a[76:77], v251 offset:34816
    ds_read_b64_tr_b16 a[78:79], v251 offset:35840
    v_mfma_f32_32x32x16_bf16 v[96:111], v[132:135], v[136:139], v[96:111]
    v_mfma_f32_32x32x16_bf16 v[112:127], v[132:135], v[140:143], v[112:127]
    s_waitcnt vmcnt(8)
    s_mov_b32 s56, 262144
L_gchk:
    v_xor_b32 v24, s47, v147
    v_xor_b32 v25, s47, v151
    v_xor_b32 v26, s47, v153
    v_xor_b32 v27, s47, v155
    v_xor_b32 v28, s47, v157
    v_xor_b32 v29, s47, v159
    v_or3_b32 v24, v24, v25, v26
    v_or3_b32 v27, v27, v28, v29
    v_or_b32 v24, v24, v27
    v_cmp_ne_u32 vcc, 0, v24
    s_cbranch_vccnz L_gslow
L_gok:
    s_waitcnt lgkmcnt(0)
    v_add_f32 v152, v152, v154
    v_add_f32 v156, v156, v158
    v_rcp_f32 v24, v146
    v_mov_b32 v153, v152
    v_mov_b32 v157, v156
    v_rcp_f32 v26, v150
    v_cmp_gt_u32 vcc, 32, v0
    v_permlane32_swap_b32 v152, v153
    v_permlane32_swap_b32 v156, v157
    v_mov_b32 v50, v146
    v_mov_b32 v54, v150
    v_add_f32 v154, v152, v153
    v_add_f32 v158, v156, v157
    v_mov_b32 v146, v144
    v_mov_b32 v150, v148
    v_cvt_pk_bf16_f32 v152, v154, v154
    v_cvt_pk_bf16_f32 v156, v158, v158
    v_lshl_or_b32 v153, v56, 16, v56
    v_lshl_or_b32 v157, v57, 16, v57
    v_lshlrev_b32 v155, 16, v152
    v_lshlrev_b32 v159, 16, v156
    v_cndmask_b32 v152, 0, v152, vcc
    v_cndmask_b32 v156, 0, v156, vcc
    v_sub_f32 v154, v154, v155
    v_sub_f32 v158, v158, v159
    v_cndmask_b32 v153, 0, v153, vcc
    v_cndmask_b32 v157, 0, v157, vcc
    v_cvt_pk_bf16_f32 v154, v154, 0
    v_cvt_pk_bf16_f32 v158, v158, 0
    v_mov_b32 v155, 0
    v_mov_b32 v159, 0
    v_cndmask_b32 v154, 0, v154, vcc
    v_cndmask_b32 v158, 0, v158, vcc
    v_mov_b32 v147, 0
    v_mov_b32 v151, 0
    s_nop 0
    v_mfma_f32_32x32x16_bf16 v[64:79], v[152:155], v[144:147], v[64:79]
    v_mfma_f32_32x32x16_bf16 v[80:95], v[152:155], v[148:151], v[80:95]
    v_mfma_f32_32x32x16_bf16 v[96:111], v[156:159], v[144:147], v[96:111]
    v_mfma_f32_32x32x16_bf16 v[112:127], v[156:159], v[148:151], v[112:127]
    v_mul_f32 v25, v24, v24
    v_mul_f32 v27, v26, v26
    v_mul_f32 v49, 0xc0135761, v24
    v_mul_f32 v53, 0xc0135761, v26
    v_mul_f32 v25, v25, v24
    v_mul_f32 v27, v27, v26
    v_mul_f32 v48, 0xbdd2d3e8, v25
    v_mul_f32 v52, 0xbdd2d3e8, v27
    v_lshlrev_b32 v56, 4, v0
    v_pk_mul_f32 v[2:3], v[64:65], v[64:65]
    v_pk_mul_f32 v[4:5], v[66:67], v[66:67]
    v_pk_mul_f32 v[6:7], v[68:69], v[68:69]
    v_pk_mul_f32 v[8:9], v[70:71], v[70:71]
    v_pk_fma_f32 v[2:3], v[2:3], v[48:49], v[48:49] op_sel:[0,0,1] op_sel_hi:[1,0,1]
    v_pk_fma_f32 v[4:5], v[4:5], v[48:49], v[48:49] op_sel:[0,0,1] op_sel_hi:[1,0,1]
    v_pk_fma_f32 v[6:7], v[6:7], v[48:49], v[48:49] op_sel:[0,0,1] op_sel_hi:[1,0,1]
    v_pk_fma_f32 v[8:9], v[8:9], v[48:49], v[48:49] op_sel:[0,0,1] op_sel_hi:[1,0,1]
    s_add_u32 m0, s69, 98304
    s_nop 0
    buffer_load_dwordx4 v246, s[64:67], s68 offen offset:0 lds
    v_pk_mul_f32 v[2:3], v[2:3], v[64:65]
    v_pk_mul_f32 v[4:5], v[4:5], v[66:67]
    v_pk_mul_f32 v[6:7], v[6:7], v[68:69]
    v_pk_mul_f32 v[8:9], v[8:9], v[70:71]
    v_exp_f32 v2, v2
    v_exp_f32 v3, v3
    v_exp_f32 v4, v4
    v_exp_f32 v5, v5
    buffer_load_dwordx4 v247, s[64:67], s68 offen offset:1024 lds
    v_exp_f32 v6, v6
    v_exp_f32 v7, v7
    v_exp_f32 v8, v8
    v_exp_f32 v9, v9
    buffer_load_dwordx4 v248, s[64:67], s68 offen offset:2048 lds
    v_pk_fma_f32 v[2:3], v[2:3], v[50:51], v[50:51] op_sel:[0,0,0] op_sel_hi:[1,0,0]
    v_pk_fma_f32 v[4:5], v[4:5], v[50:51], v[50:51] op_sel:[0,0,0] op_sel_hi:[1,0,0]
    v_pk_fma_f32 v[6:7], v[6:7], v[50:51], v[50:51] op_sel:[0,0,0] op_sel_hi:[1,0,0]
    v_pk_fma_f32 v[8:9], v[8:9], v[50:51], v[50:51] op_sel:[0,0,0] op_sel_hi:[1,0,0]
    v_rcp_f32 v2, v2
    v_rcp_f32 v3, v3
    v_rcp_f32 v4, v4
    v_rcp_f32 v5, v5
    v_rcp_f32 v6, v6
    v_rcp_f32 v7, v7
    v_rcp_f32 v8, v8
    v_rcp_f32 v9, v9
    buffer_load_dwordx4 v249, s[64:67], s68 offen offset:3072 lds
    s_add_u32 s68, s68, 32768
    s_cmp_eq_u32 s68, 458752
    s_cselect_b32 s68, 0, s68
    v_pk_mul_f32 v[2:3], v[2:3], v[64:65]
    v_pk_mul_f32 v[4:5], v[4:5], v[66:67]
    v_pk_mul_f32 v[6:7], v[6:7], v[68:69]
    v_pk_mul_f32 v[8:9], v[8:9], v[70:71]
    v_cvt_pk_bf16_f32 v24, v2, v3
    v_cvt_pk_bf16_f32 v25, v4, v5
    v_cvt_pk_bf16_f32 v26, v6, v7
    v_cvt_pk_bf16_f32 v27, v8, v9
    buffer_store_dwordx4 v[24:27], v56, s[36:39], s60 offen offset:0 sc1
    v_pk_mul_f32 v[2:3], v[72:73], v[72:73]
    v_pk_mul_f32 v[4:5], v[74:75], v[74:75]
    v_pk_mul_f32 v[6:7], v[76:77], v[76:77]
    v_pk_mul_f32 v[8:9], v[78:79], v[78:79]
    v_pk_fma_f32 v[2:3], v[2:3], v[48:49], v[48:49] op_sel:[0,0,1] op_sel_hi:[1,0,1]
    v_pk_fma_f32 v[4:5], v[4:5], v[48:49], v[48:49] op_sel:[0,0,1] op_sel_hi:[1,0,1]
    v_pk_fma_f32 v[6:7], v[6:7], v[48:49], v[48:49] op_sel:[0,0,1] op_sel_hi:[1,0,1]
    v_pk_fma_f32 v[8:9], v[8:9], v[48:49], v[48:49] op_sel:[0,0,1] op_sel_hi:[1,0,1]
    s_add_u32 m0, s69, 102400
    s_nop 0
    buffer_load_dwordx4 v246, s[64:67], s68 offen offset:0 lds
    v_pk_mul_f32 v[2:3], v[2:3], v[72:73]
    v_pk_mul_f32 v[4:5], v[4:5], v[74:75]
    v_pk_mul_f32 v[6:7], v[6:7], v[76:77]
    v_pk_mul_f32 v[8:9], v[8:9], v[78:79]
    v_exp_f32 v2, v2
    v_exp_f32 v3, v3
    v_exp_f32 v4, v4
    v_exp_f32 v5, v5
    buffer_load_dwordx4 v247, s[64:67], s68 offen offset:1024 lds
    v_exp_f32 v6, v6
    v_exp_f32 v7, v7
    v_exp_f32 v8, v8
    v_exp_f32 v9, v9
    buffer_load_dwordx4 v248, s[64:67], s68 offen offset:2048 lds
    v_pk_fma_f32 v[2:3], v[2:3], v[50:51], v[50:51] op_sel:[0,0,0] op_sel_hi:[1,0,0]
    v_pk_fma_f32 v[4:5], v[4:5], v[50:51], v[50:51] op_sel:[0,0,0] op_sel_hi:[1,0,0]
    v_pk_fma_f32 v[6:7], v[6:7], v[50:51], v[50:51] op_sel:[0,0,0] op_sel_hi:[1,0,0]
    v_pk_fma_f32 v[8:9], v[8:9], v[50:51], v[50:51] op_sel:[0,0,0] op_sel_hi:[1,0,0]
    v_rcp_f32 v2, v2
    v_rcp_f32 v3, v3
    v_rcp_f32 v4, v4
    v_rcp_f32 v5, v5
    v_rcp_f32 v6, v6
    v_rcp_f32 v7, v7
    v_rcp_f32 v8, v8
    v_rcp_f32 v9, v9
    buffer_load_dwordx4 v249, s[64:67], s68 offen offset:3072 lds
    s_add_u32 s68, s68, 32768
    s_cmp_eq_u32 s68, 458752
    s_cselect_b32 s68, 0, s68
    v_pk_mul_f32 v[2:3], v[2:3], v[72:73]
    v_pk_mul_f32 v[4:5], v[4:5], v[74:75]
    v_pk_mul_f32 v[6:7], v[6:7], v[76:77]
    v_pk_mul_f32 v[8:9], v[8:9], v[78:79]
    v_cvt_pk_bf16_f32 v28, v2, v3
    v_cvt_pk_bf16_f32 v29, v4, v5
    v_cvt_pk_bf16_f32 v30, v6, v7
    v_cvt_pk_bf16_f32 v31, v8, v9
    buffer_store_dwordx4 v[28:31], v56, s[36:39], s60 offen offset:2048 sc1
    v_pk_mul_f32 v[2:3], v[80:81], v[80:81]
    v_pk_mul_f32 v[4:5], v[82:83], v[82:83]
    v_pk_mul_f32 v[6:7], v[84:85], v[84:85]
    v_pk_mul_f32 v[8:9], v[86:87], v[86:87]
    v_pk_fma_f32 v[2:3], v[2:3], v[52:53], v[52:53] op_sel:[0,0,1] op_sel_hi:[1,0,1]
    v_pk_fma_f32 v[4:5], v[4:5], v[52:53], v[52:53] op_sel:[0,0,1] op_sel_hi:[1,0,1]
    v_pk_fma_f32 v[6:7], v[6:7], v[52:53], v[52:53] op_sel:[0,0,1] op_sel_hi:[1,0,1]
    v_pk_fma_f32 v[8:9], v[8:9], v[52:53], v[52:53] op_sel:[0,0,1] op_sel_hi:[1,0,1]
    buffer_load_ushort v254, v254, s[72:75], 0 offen
    v_pk_mul_f32 v[2:3], v[2:3], v[80:81]
    v_pk_mul_f32 v[4:5], v[4:5], v[82:83]
    v_pk_mul_f32 v[6:7], v[6:7], v[84:85]
    v_pk_mul_f32 v[8:9], v[8:9], v[86:87]
    v_exp_f32 v2, v2
    v_exp_f32 v3, v3
    v_exp_f32 v4, v4
    v_exp_f32 v5, v5
    v_exp_f32 v6, v6
    v_exp_f32 v7, v7
    v_exp_f32 v8, v8
    v_exp_f32 v9, v9
    v_pk_fma_f32 v[2:3], v[2:3], v[54:55], v[54:55] op_sel:[0,0,0] op_sel_hi:[1,0,0]
    v_pk_fma_f32 v[4:5], v[4:5], v[54:55], v[54:55] op_sel:[0,0,0] op_sel_hi:[1,0,0]
    v_pk_fma_f32 v[6:7], v[6:7], v[54:55], v[54:55] op_sel:[0,0,0] op_sel_hi:[1,0,0]
    v_pk_fma_f32 v[8:9], v[8:9], v[54:55], v[54:55] op_sel:[0,0,0] op_sel_hi:[1,0,0]
    v_rcp_f32 v2, v2
    v_rcp_f32 v3, v3
    v_rcp_f32 v4, v4
    v_rcp_f32 v5, v5
    v_rcp_f32 v6, v6
    v_rcp_f32 v7, v7
    v_rcp_f32 v8, v8
    v_rcp_f32 v9, v9
    v_pk_mul_f32 v[2:3], v[2:3], v[80:81]
    v_pk_mul_f32 v[4:5], v[4:5], v[82:83]
    v_pk_mul_f32 v[6:7], v[6:7], v[84:85]
    v_pk_mul_f32 v[8:9], v[8:9], v[86:87]
    v_cvt_pk_bf16_f32 v24, v2, v3
    v_cvt_pk_bf16_f32 v25, v4, v5
    v_cvt_pk_bf16_f32 v26, v6, v7
    v_cvt_pk_bf16_f32 v27, v8, v9
    buffer_store_dwordx4 v[24:27], v56, s[36:39], s61 offen offset:0 sc1
    v_pk_mul_f32 v[2:3], v[88:89], v[88:89]
    v_pk_mul_f32 v[4:5], v[90:91], v[90:91]
    v_pk_mul_f32 v[6:7], v[92:93], v[92:93]
    v_pk_mul_f32 v[8:9], v[94:95], v[94:95]
    v_pk_fma_f32 v[2:3], v[2:3], v[52:53], v[52:53] op_sel:[0,0,1] op_sel_hi:[1,0,1]
    v_pk_fma_f32 v[4:5], v[4:5], v[52:53], v[52:53] op_sel:[0,0,1] op_sel_hi:[1,0,1]
    v_pk_fma_f32 v[6:7], v[6:7], v[52:53], v[52:53] op_sel:[0,0,1] op_sel_hi:[1,0,1]
    v_pk_fma_f32 v[8:9], v[8:9], v[52:53], v[52:53] op_sel:[0,0,1] op_sel_hi:[1,0,1]
    v_pk_mul_f32 v[2:3], v[2:3], v[88:89]
    v_pk_mul_f32 v[4:5], v[4:5], v[90:91]
    v_pk_mul_f32 v[6:7], v[6:7], v[92:93]
    v_pk_mul_f32 v[8:9], v[8:9], v[94:95]
    v_exp_f32 v2, v2
    v_exp_f32 v3, v3
    v_exp_f32 v4, v4
    v_exp_f32 v5, v5
    v_exp_f32 v6, v6
    v_exp_f32 v7, v7
    v_exp_f32 v8, v8
    v_exp_f32 v9, v9
    v_pk_fma_f32 v[2:3], v[2:3], v[54:55], v[54:55] op_sel:[0,0,0] op_sel_hi:[1,0,0]
    v_pk_fma_f32 v[4:5], v[4:5], v[54:55], v[54:55] op_sel:[0,0,0] op_sel_hi:[1,0,0]
    v_pk_fma_f32 v[6:7], v[6:7], v[54:55], v[54:55] op_sel:[0,0,0] op_sel_hi:[1,0,0]
    v_pk_fma_f32 v[8:9], v[8:9], v[54:55], v[54:55] op_sel:[0,0,0] op_sel_hi:[1,0,0]
    v_rcp_f32 v2, v2
    v_rcp_f32 v3, v3
    v_rcp_f32 v4, v4
    v_rcp_f32 v5, v5
    v_rcp_f32 v6, v6
    v_rcp_f32 v7, v7
    v_rcp_f32 v8, v8
    v_rcp_f32 v9, v9
    v_pk_mul_f32 v[2:3], v[2:3], v[88:89]
    v_pk_mul_f32 v[4:5], v[4:5], v[90:91]
    v_pk_mul_f32 v[6:7], v[6:7], v[92:93]
    v_pk_mul_f32 v[8:9], v[8:9], v[94:95]
    v_cvt_pk_bf16_f32 v28, v2, v3
    v_cvt_pk_bf16_f32 v29, v4, v5
    v_cvt_pk_bf16_f32 v30, v6, v7
    v_cvt_pk_bf16_f32 v31, v8, v9
    buffer_store_dwordx4 v[28:31], v56, s[36:39], s61 offen offset:2048 sc1
    v_pk_mul_f32 v[2:3], v[96:97], v[96:97]
    v_pk_mul_f32 v[4:5], v[98:99], v[98:99]
    v_pk_mul_f32 v[6:7], v[100:101], v[100:101]
    v_pk_mul_f32 v[8:9], v[102:103], v[102:103]
    v_pk_fma_f32 v[2:3], v[2:3], v[48:49], v[48:49] op_sel:[0,0,1] op_sel_hi:[1,0,1]
    v_pk_fma_f32 v[4:5], v[4:5], v[48:49], v[48:49] op_sel:[0,0,1] op_sel_hi:[1,0,1]
    v_pk_fma_f32 v[6:7], v[6:7], v[48:49], v[48:49] op_sel:[0,0,1] op_sel_hi:[1,0,1]
    v_pk_fma_f32 v[8:9], v[8:9], v[48:49], v[48:49] op_sel:[0,0,1] op_sel_hi:[1,0,1]
    v_pk_mul_f32 v[2:3], v[2:3], v[96:97]
    v_pk_mul_f32 v[4:5], v[4:5], v[98:99]
    v_pk_mul_f32 v[6:7], v[6:7], v[100:101]
    v_pk_mul_f32 v[8:9], v[8:9], v[102:103]
    v_exp_f32 v2, v2
    v_exp_f32 v3, v3
    v_exp_f32 v4, v4
    v_exp_f32 v5, v5
    v_exp_f32 v6, v6
    v_exp_f32 v7, v7
    v_exp_f32 v8, v8
    v_exp_f32 v9, v9
    v_pk_fma_f32 v[2:3], v[2:3], v[50:51], v[50:51] op_sel:[0,0,0] op_sel_hi:[1,0,0]
    v_pk_fma_f32 v[4:5], v[4:5], v[50:51], v[50:51] op_sel:[0,0,0] op_sel_hi:[1,0,0]
    v_pk_fma_f32 v[6:7], v[6:7], v[50:51], v[50:51] op_sel:[0,0,0] op_sel_hi:[1,0,0]
    v_pk_fma_f32 v[8:9], v[8:9], v[50:51], v[50:51] op_sel:[0,0,0] op_sel_hi:[1,0,0]
    v_rcp_f32 v2, v2
    v_rcp_f32 v3, v3
    v_rcp_f32 v4, v4
    v_rcp_f32 v5, v5
    v_rcp_f32 v6, v6
    v_rcp_f32 v7, v7
    v_rcp_f32 v8, v8
    v_rcp_f32 v9, v9
    v_pk_mul_f32 v[2:3], v[2:3], v[96:97]
    v_pk_mul_f32 v[4:5], v[4:5], v[98:99]
    v_pk_mul_f32 v[6:7], v[6:7], v[100:101]
    v_pk_mul_f32 v[8:9], v[8:9], v[102:103]
    v_cvt_pk_bf16_f32 v24, v2, v3
    v_cvt_pk_bf16_f32 v25, v4, v5
    v_cvt_pk_bf16_f32 v26, v6, v7
    v_cvt_pk_bf16_f32 v27, v8, v9
    buffer_store_dwordx4 v[24:27], v56, s[36:39], s62 offen offset:0 sc1
    v_pk_mul_f32 v[2:3], v[104:105], v[104:105]
    v_pk_mul_f32 v[4:5], v[106:107], v[106:107]
    v_pk_mul_f32 v[6:7], v[108:109], v[108:109]
    v_pk_mul_f32 v[8:9], v[110:111], v[110:111]
    v_pk_fma_f32 v[2:3], v[2:3], v[48:49], v[48:49] op_sel:[0,0,1] op_sel_hi:[1,0,1]
    v_pk_fma_f32 v[4:5], v[4:5], v[48:49], v[48:49] op_sel:[0,0,1] op_sel_hi:[1,0,1]
    v_pk_fma_f32 v[6:7], v[6:7], v[48:49], v[48:49] op_sel:[0,0,1] op_sel_hi:[1,0,1]
    v_pk_fma_f32 v[8:9], v[8:9], v[48:49], v[48:49] op_sel:[0,0,1] op_sel_hi:[1,0,1]
    v_pk_mul_f32 v[2:3], v[2:3], v[104:105]
    v_pk_mul_f32 v[4:5], v[4:5], v[106:107]
    v_pk_mul_f32 v[6:7], v[6:7], v[108:109]
    v_pk_mul_f32 v[8:9], v[8:9], v[110:111]
    v_exp_f32 v2, v2
    v_exp_f32 v3, v3
    v_exp_f32 v4, v4
    v_exp_f32 v5, v5
    v_exp_f32 v6, v6
    v_exp_f32 v7, v7
    v_exp_f32 v8, v8
    v_exp_f32 v9, v9
    v_pk_fma_f32 v[2:3], v[2:3], v[50:51], v[50:51] op_sel:[0,0,0] op_sel_hi:[1,0,0]
    v_pk_fma_f32 v[4:5], v[4:5], v[50:51], v[50:51] op_sel:[0,0,0] op_sel_hi:[1,0,0]
    v_pk_fma_f32 v[6:7], v[6:7], v[50:51], v[50:51] op_sel:[0,0,0] op_sel_hi:[1,0,0]
    v_pk_fma_f32 v[8:9], v[8:9], v[50:51], v[50:51] op_sel:[0,0,0] op_sel_hi:[1,0,0]
    v_rcp_f32 v2, v2
    v_rcp_f32 v3, v3
    v_rcp_f32 v4, v4
    v_rcp_f32 v5, v5
    v_rcp_f32 v6, v6
    v_rcp_f32 v7, v7
    v_rcp_f32 v8, v8
    v_rcp_f32 v9, v9
    v_pk_mul_f32 v[2:3], v[2:3], v[104:105]
    v_pk_mul_f32 v[4:5], v[4:5], v[106:107]
    v_pk_mul_f32 v[6:7], v[6:7], v[108:109]
    v_pk_mul_f32 v[8:9], v[8:9], v[110:111]
    v_cvt_pk_bf16_f32 v28, v2, v3
    v_cvt_pk_bf16_f32 v29, v4, v5
    v_cvt_pk_bf16_f32 v30, v6, v7
    v_cvt_pk_bf16_f32 v31, v8, v9
    buffer_store_dwordx4 v[28:31], v56, s[36:39], s62 offen offset:2048 sc1
    v_pk_mul_f32 v[2:3], v[112:113], v[112:113]
    v_pk_mul_f32 v[4:5], v[114:115], v[114:115]
    v_pk_mul_f32 v[6:7], v[116:117], v[116:117]
    v_pk_mul_f32 v[8:9], v[118:119], v[118:119]
    v_pk_fma_f32 v[2:3], v[2:3], v[52:53], v[52:53] op_sel:[0,0,1] op_sel_hi:[1,0,1]
    v_pk_fma_f32 v[4:5], v[4:5], v[52:53], v[52:53] op_sel:[0,0,1] op_sel_hi:[1,0,1]
    v_pk_fma_f32 v[6:7], v[6:7], v[52:53], v[52:53] op_sel:[0,0,1] op_sel_hi:[1,0,1]
    v_pk_fma_f32 v[8:9], v[8:9], v[52:53], v[52:53] op_sel:[0,0,1] op_sel_hi:[1,0,1]
    v_pk_mul_f32 v[2:3], v[2:3], v[112:113]
    v_pk_mul_f32 v[4:5], v[4:5], v[114:115]
    v_pk_mul_f32 v[6:7], v[6:7], v[116:117]
    v_pk_mul_f32 v[8:9], v[8:9], v[118:119]
    v_exp_f32 v2, v2
    v_exp_f32 v3, v3
    v_exp_f32 v4, v4
    v_exp_f32 v5, v5
    v_exp_f32 v6, v6
    v_exp_f32 v7, v7
    v_exp_f32 v8, v8
    v_exp_f32 v9, v9
    v_pk_fma_f32 v[2:3], v[2:3], v[54:55], v[54:55] op_sel:[0,0,0] op_sel_hi:[1,0,0]
    v_pk_fma_f32 v[4:5], v[4:5], v[54:55], v[54:55] op_sel:[0,0,0] op_sel_hi:[1,0,0]
    v_pk_fma_f32 v[6:7], v[6:7], v[54:55], v[54:55] op_sel:[0,0,0] op_sel_hi:[1,0,0]
    v_pk_fma_f32 v[8:9], v[8:9], v[54:55], v[54:55] op_sel:[0,0,0] op_sel_hi:[1,0,0]
    v_rcp_f32 v2, v2
    v_rcp_f32 v3, v3
    v_rcp_f32 v4, v4
    v_rcp_f32 v5, v5
    v_rcp_f32 v6, v6
    v_rcp_f32 v7, v7
    v_rcp_f32 v8, v8
    v_rcp_f32 v9, v9
    v_pk_mul_f32 v[2:3], v[2:3], v[112:113]
    v_pk_mul_f32 v[4:5], v[4:5], v[114:115]
    v_pk_mul_f32 v[6:7], v[6:7], v[116:117]
    v_pk_mul_f32 v[8:9], v[8:9], v[118:119]
    v_cvt_pk_bf16_f32 v24, v2, v3
    v_cvt_pk_bf16_f32 v25, v4, v5
    v_cvt_pk_bf16_f32 v26, v6, v7
    v_cvt_pk_bf16_f32 v27, v8, v9
    buffer_store_dwordx4 v[24:27], v56, s[36:39], s63 offen offset:0 sc1
    v_pk_mul_f32 v[2:3], v[120:121], v[120:121]
    v_pk_mul_f32 v[4:5], v[122:123], v[122:123]
    v_pk_mul_f32 v[6:7], v[124:125], v[124:125]
    v_pk_mul_f32 v[8:9], v[126:127], v[126:127]
    v_pk_fma_f32 v[2:3], v[2:3], v[52:53], v[52:53] op_sel:[0,0,1] op_sel_hi:[1,0,1]
    v_pk_fma_f32 v[4:5], v[4:5], v[52:53], v[52:53] op_sel:[0,0,1] op_sel_hi:[1,0,1]
    v_pk_fma_f32 v[6:7], v[6:7], v[52:53], v[52:53] op_sel:[0,0,1] op_sel_hi:[1,0,1]
    v_pk_fma_f32 v[8:9], v[8:9], v[52:53], v[52:53] op_sel:[0,0,1] op_sel_hi:[1,0,1]
    v_pk_mul_f32 v[2:3], v[2:3], v[120:121]
    v_pk_mul_f32 v[4:5], v[4:5], v[122:123]
    v_pk_mul_f32 v[6:7], v[6:7], v[124:125]
    v_pk_mul_f32 v[8:9], v[8:9], v[126:127]
    v_exp_f32 v2, v2
    v_exp_f32 v3, v3
    v_exp_f32 v4, v4
    v_exp_f32 v5, v5
    v_exp_f32 v6, v6
    v_exp_f32 v7, v7
    v_exp_f32 v8, v8
    v_exp_f32 v9, v9
    v_pk_fma_f32 v[2:3], v[2:3], v[54:55], v[54:55] op_sel:[0,0,0] op_sel_hi:[1,0,0]
    v_pk_fma_f32 v[4:5], v[4:5], v[54:55], v[54:55] op_sel:[0,0,0] op_sel_hi:[1,0,0]
    v_pk_fma_f32 v[6:7], v[6:7], v[54:55], v[54:55] op_sel:[0,0,0] op_sel_hi:[1,0,0]
    v_pk_fma_f32 v[8:9], v[8:9], v[54:55], v[54:55] op_sel:[0,0,0] op_sel_hi:[1,0,0]
    v_rcp_f32 v2, v2
    v_rcp_f32 v3, v3
    v_rcp_f32 v4, v4
    v_rcp_f32 v5, v5
    v_rcp_f32 v6, v6
    v_rcp_f32 v7, v7
    v_rcp_f32 v8, v8
    v_rcp_f32 v9, v9
    v_pk_mul_f32 v[2:3], v[2:3], v[120:121]
    v_pk_mul_f32 v[4:5], v[4:5], v[122:123]
    v_pk_mul_f32 v[6:7], v[6:7], v[124:125]
    v_pk_mul_f32 v[8:9], v[8:9], v[126:127]
    v_cvt_pk_bf16_f32 v28, v2, v3
    v_cvt_pk_bf16_f32 v29, v4, v5
    v_cvt_pk_bf16_f32 v30, v6, v7
    v_cvt_pk_bf16_f32 v31, v8, v9
    buffer_store_dwordx4 v[28:31], v56, s[36:39], s63 offen offset:2048 sc1
    v_mov_b32 v2, s47
    v_add_u32 v14, 0x10000, v250
    v_add_u32 v15, 0x10000, v251
    v_add_u32 v241, 0, v250
    v_add_u32 v242, 0, v251
    v_add_u32 v243, 131072, v250
    v_add_u32 v244, 131072, v251
    s_add_u32 s6, s69, 32768
    s_xor_b32 s9, s6, 8192
    s_add_u32 s7, s69, 65536
    s_xor_b32 s10, s7, 16384
    s_add_u32 s8, s69, 98304
    s_xor_b32 s11, s8, 24576
    s_add_u32 s12, s69, 36864
    ds_read_b64_tr_b16 a[80:81], v250 offset:36864
    ds_read_b64_tr_b16 a[82:83], v250 offset:37888
    ds_read_b64_tr_b16 a[84:85], v251 offset:36864
    ds_read_b64_tr_b16 a[86:87], v251 offset:37888
    ds_read_b64_tr_b16 a[88:89], v250 offset:38912
    ds_read_b64_tr_b16 a[90:91], v250 offset:39936
    ds_read_b64_tr_b16 a[92:93], v251 offset:38912
    ds_read_b64_tr_b16 a[94:95], v251 offset:39936
    s_waitcnt vmcnt(21)
    ds_read_b64_tr_b16 a[96:97], v14 offset:0
    ds_read_b64_tr_b16 a[98:99], v14 offset:1024
    ds_read_b64_tr_b16 a[100:101], v15 offset:0
    ds_read_b64_tr_b16 a[102:103], v15 offset:1024
    ds_read_b64_tr_b16 a[104:105], v14 offset:2048
    ds_read_b64_tr_b16 a[106:107], v14 offset:3072
    ds_read_b64_tr_b16 a[108:109], v15 offset:2048
    ds_read_b64_tr_b16 a[110:111], v15 offset:3072
    s_waitcnt vmcnt(17)
    ds_read_b64_tr_b16 a[112:113], v14 offset:4096
    ds_read_b64_tr_b16 a[114:115], v14 offset:5120
    ds_read_b64_tr_b16 a[116:117], v15 offset:4096
    ds_read_b64_tr_b16 a[118:119], v15 offset:5120
    ds_read_b64_tr_b16 a[120:121], v14 offset:6144
    ds_read_b64_tr_b16 a[122:123], v14 offset:7168
    ds_read_b64_tr_b16 a[124:125], v15 offset:6144
    ds_read_b64_tr_b16 a[126:127], v15 offset:7168
    s_waitcnt vmcnt(13)
    ds_read_b64_tr_b16 a[128:129], v252 offset:0
    ds_read_b64_tr_b16 a[130:131], v252 offset:1024
    ds_read_b64_tr_b16 a[132:133], v253 offset:0
    ds_read_b64_tr_b16 a[134:135], v253 offset:1024
    ds_read_b64_tr_b16 a[136:137], v252 offset:2048
    ds_read_b64_tr_b16 a[138:139], v252 offset:3072
    ds_read_b64_tr_b16 a[140:141], v253 offset:2048
    ds_read_b64_tr_b16 a[142:143], v253 offset:3072
    s_waitcnt vmcnt(8)
    ds_read_b64_tr_b16 a[144:145], v252 offset:4096
    ds_read_b64_tr_b16 a[146:147], v252 offset:5120
    ds_read_b64_tr_b16 a[148:149], v253 offset:4096
    ds_read_b64_tr_b16 a[150:151], v253 offset:5120
    ds_read_b64_tr_b16 a[152:153], v252 offset:6144
    ds_read_b64_tr_b16 a[154:155], v252 offset:7168
    ds_read_b64_tr_b16 a[156:157], v253 offset:6144
    ds_read_b64_tr_b16 a[158:159], v253 offset:7168
    s_mov_b32 s36, s28
    s_mov_b32 s37, s29
    s_mov_b32 s38, 7340032
    s_mov_b32 s39, 0x20000
    s_add_u32 s32, s28, 8388608
    s_addc_u32 s33, s29, 0
    s_mov_b32 s34, 4194304
    s_mov_b32 s35, 0x20000
    s_mov_b32 s72, s24
    s_mov_b32 s73, s25
    s_mov_b32 s74, 2097152
    s_mov_b32 s75, 0x20000
    s_sub_u32 s62, 32, s71
    s_and_b32 s62, s62, 31
    s_cmp_lt_u32 s70, 4
    s_cselect_b32 s62, s71, s62
    s_lshl_b32 s62, s62, 16
    v_mov_b32 v185, 0
    v_mov_b32 v186, 0
    v_mov_b32 v187, 0
    v_mov_b32 v188, 0x3f80
    v_cmp_gt_u32 vcc, 32, v0
    v_mov_b32 v189, 0
    v_mov_b32 v190, 0
    v_cndmask_b32 v188, 0, v188, vcc
    v_mov_b32 v191, 0
    s_mul_i32 s57, s71, 112
    s_mul_i32 s53, s3, 28
    s_add_u32 s57, s57, s53
    s_lshl_b32 s57, s57, 11
    s_add_u32 s59, s57, 57344
    s_lshl_b32 s53, s44, 12
    s_add_u32 s58, s57, s53
    v_mov_b32 v2, s47
    s_mov_b32 s56, 262144
    v_lshl_add_u32 v10, v0, 4, s6
    v_lshl_add_u32 v11, v0, 4, s7
    v_lshl_add_u32 v12, v0, 4, s8
    v_mov_b32 v9, v62
    s_waitcnt vmcnt(0)
    s_barrier
    buffer_store_dword v2, v58, s[40:43], 0 offen sc1
    s_waitcnt lgkmcnt(0)
    s_add_u32 m0, s69, 131072
    s_nop 0
    buffer_load_dwordx4 v246, s[64:67], s68 offen offset:0 lds
    buffer_load_dwordx4 v247, s[64:67], s68 offen offset:1024 lds
    buffer_load_dwordx4 v248, s[64:67], s68 offen offset:2048 lds
    buffer_load_dwordx4 v249, s[64:67], s68 offen offset:3072 lds
    s_add_u32 s68, s68, 32768
    s_cmp_eq_u32 s68, 458752
    s_cselect_b32 s68, 0, s68
    s_add_u32 m0, s69, 135168
    s_nop 0
    buffer_load_dwordx4 v246, s[64:67], s68 offen offset:0 lds
    buffer_load_dwordx4 v247, s[64:67], s68 offen offset:1024 lds
    buffer_load_dwordx4 v248, s[64:67], s68 offen offset:2048 lds
    buffer_load_dwordx4 v249, s[64:67], s68 offen offset:3072 lds
    s_add_u32 s68, s68, 32768
    s_cmp_eq_u32 s68, 458752
    s_cselect_b32 s68, 0, s68
    s_add_u32 m0, s69, 0
    s_nop 0
    buffer_load_dwordx4 v246, s[64:67], s68 offen offset:0 lds
    buffer_load_dwordx4 v247, s[64:67], s68 offen offset:1024 lds
    buffer_load_dwordx4 v248, s[64:67], s68 offen offset:2048 lds
    buffer_load_dwordx4 v249, s[64:67], s68 offen offset:3072 lds
    s_add_u32 s68, s68, 32768
    s_cmp_eq_u32 s68, 458752
    s_cselect_b32 s68, 0, s68
    s_add_u32 m0, s69, 4096
    s_nop 0
    buffer_load_dwordx4 v246, s[64:67], s68 offen offset:0 lds
    buffer_load_dwordx4 v247, s[64:67], s68 offen offset:1024 lds
    buffer_load_dwordx4 v248, s[64:67], s68 offen offset:2048 lds
    buffer_load_dwordx4 v249, s[64:67], s68 offen offset:3072 lds
    v_not_b32 v3, v2
    buffer_load_dword v3, v63, s[40:43], 0 offen sc1
    v_mov_b32 v184, v254
    s_waitcnt vmcnt(0)
    v_cmp_ne_u32 vcc, s47, v3
    s_cbranch_vccnz L_pslow_m
L_go_m:
    s_waitcnt lgkmcnt(0)
    s_mov_b32 s55, 0x80000
    buffer_load_dwordx4 v[16:19], v59, s[36:39], s58 offen offset:0 sc1
    buffer_load_dwordx4 v[20:23], v60, s[36:39], s58 offen offset:0 sc1
    buffer_load_dwordx4 v[24:27], v59, s[36:39], s58 offen offset:2048 sc1
    buffer_load_dwordx4 v[28:31], v60, s[36:39], s58 offen offset:2048 sc1
    s_add_u32 s58, s58, 4096
    s_cmp_eq_u32 s58, s59
    s_cselect_b32 s58, s57, s58
    buffer_load_dwordx4 v[32:35], v59, s[36:39], s58 offen offset:0 sc1
    buffer_load_dwordx4 v[36:39], v60, s[36:39], s58 offen offset:0 sc1
    buffer_load_dwordx4 v[40:43], v59, s[36:39], s58 offen offset:2048 sc1
    buffer_load_dwordx4 v[44:47], v60, s[36:39], s58 offen offset:2048 sc1
    s_add_u32 s58, s58, 4096
    s_cmp_eq_u32 s58, s59
    s_cselect_b32 s58, s57, s58
    buffer_load_dwordx4 v[48:51], v59, s[36:39], s58 offen offset:0 sc1
    buffer_load_dwordx4 v[52:55], v60, s[36:39], s58 offen offset:0 sc1
    buffer_load_dwordx4 v[192:195], v59, s[36:39], s58 offen offset:2048 sc1
    buffer_load_dwordx4 v[196:199], v60, s[36:39], s58 offen offset:2048 sc1
    s_add_u32 s58, s58, 4096
    s_cmp_eq_u32 s58, s59
    s_cselect_b32 s58, s57, s58
    buffer_load_dwordx4 v[200:203], v59, s[36:39], s58 offen offset:0 sc1
    buffer_load_dwordx4 v[204:207], v60, s[36:39], s58 offen offset:0 sc1
    buffer_load_dwordx4 v[208:211], v59, s[36:39], s58 offen offset:2048 sc1
    buffer_load_dwordx4 v[212:215], v60, s[36:39], s58 offen offset:2048 sc1
    s_add_u32 s58, s58, 4096
    s_cmp_eq_u32 s58, s59
    s_cselect_b32 s58, s57, s58
    v_mfma_f32_32x32x16_bf16 v[64:79], v[184:187], v[188:191], 0
    s_waitcnt vmcnt(14)
    v_mfma_f32_32x32x16_bf16 v[64:79], a[0:3], v[16:19], v[64:79]
    v_and_b32 v236, 31, v0
    v_lshrrev_b32 v237, 5, v0
    v_lshlrev_b32 v237, 3, v237
    v_lshl_add_u32 v237, v236, 6, v237
    v_mfma_f32_32x32x16_bf16 v[80:95], a[4:7], v[16:19], 0
    v_bfe_u32 v236, v0, 2, 2
    v_lshl_add_u32 v236, v236, 4, v237
    v_add_u32 v236, s12, v236
    v_xor_b32 v237, 16, v236
    v_mfma_f32_32x32x16_bf16 v[96:111], a[0:3], v[20:23], 0
    v_xor_b32 v238, 32, v236
    v_xor_b32 v239, 48, v236
    v_lshl_add_u32 v240, v0, 4, s12
    s_cmp_lt_u32 s70, 4
    s_cselect_b32 s0, 0, 0x80000000
    v_mfma_f32_32x32x16_bf16 v[112:127], a[4:7], v[20:23], 0
    buffer_load_dwordx4 v[216:219], v59, s[36:39], s58 offen offset:0 sc1
    buffer_load_dwordx4 v[220:223], v60, s[36:39], s58 offen offset:0 sc1
    s_waitcnt vmcnt(14)
    v_mfma_f32_32x32x16_bf16 v[64:79], a[8:11], v[24:27], v[64:79]
    ds_read_b64_tr_b16 a[160:161], v243 offset:0
    ds_read_b64_tr_b16 a[162:163], v243 offset:1024
    ds_read_b64_tr_b16 a[164:165], v244 offset:0
    ds_read_b64_tr_b16 a[166:167], v244 offset:1024
    v_mfma_f32_32x32x16_bf16 v[80:95], a[12:15], v[24:27], v[80:95]
    s_or_b32 s0, s0, 0x3a000000
    v_mov_b32 v13, v245
    v_lshrrev_b32 v14, 5, v0
    v_cvt_f32_u32 v13, v13
    v_mfma_f32_32x32x16_bf16 v[96:111], a[8:11], v[28:31], v[96:111]
    v_cvt_f32_u32 v14, v14
    v_mul_f32 v13, s0, v13
    v_cmp_gt_u32 s[0:1], 32, v0
    v_mul_f32 v14, v14, v13
    v_mfma_f32_32x32x16_bf16 v[112:127], a[12:15], v[28:31], v[112:127]
    buffer_load_dwordx4 v[224:227], v59, s[36:39], s58 offen offset:2048 sc1
    buffer_load_dwordx4 v[228:231], v60, s[36:39], s58 offen offset:2048 sc1
    s_add_u32 s58, s58, 4096
    s_cmp_eq_u32 s58, s59
    s_cselect_b32 s58, s57, s58
    s_waitcnt vmcnt(14)
    v_mfma_f32_32x32x16_bf16 v[64:79], a[16:19], v[32:35], v[64:79]
    ds_read_b64_tr_b16 a[168:169], v243 offset:2048
    ds_read_b64_tr_b16 a[170:171], v243 offset:3072
    ds_read_b64_tr_b16 a[172:173], v244 offset:2048
    ds_read_b64_tr_b16 a[174:175], v244 offset:3072
    v_mfma_f32_32x32x16_bf16 v[80:95], a[20:23], v[32:35], v[80:95]
    v_mul_f32 v15, 0x42000000, v13
    v_add_f32 v13, v13, v13
    v_mul_f32 v8, 0.5, v15
    v_cndmask_b32 v8, v15, v8, s[0:1]
    v_mfma_f32_32x32x16_bf16 v[96:111], a[16:19], v[36:39], v[96:111]
    v_add_f32 v5, v14, v15
    v_sub_f32 v6, v8, v14
    v_add_f32 v7, v6, v15
    v_cos_f32 v128, v14
    v_mfma_f32_32x32x16_bf16 v[112:127], a[20:23], v[36:39], v[112:127]
    buffer_load_dwordx4 v[16:19], v59, s[36:39], s58 offen offset:0 sc1
    buffer_load_dwordx4 v[20:23], v60, s[36:39], s58 offen offset:0 sc1
    s_mov_b32 m0, s12
    s_nop 0
    buffer_load_dwordx4 v255, s[76:79], 0 offen lds
    s_add_u32 m0, m0, 1024
    s_nop 0
    buffer_load_dwordx4 v255, s[76:79], s55 offen lds
    s_waitcnt vmcnt(16)
    v_mfma_f32_32x32x16_bf16 v[64:79], a[24:27], v[40:43], v[64:79]
    ds_read_b64_tr_b16 a[176:177], v243 offset:4096
    ds_read_b64_tr_b16 a[178:179], v243 offset:5120
    ds_read_b64_tr_b16 a[180:181], v244 offset:4096
    ds_read_b64_tr_b16 a[182:183], v244 offset:5120
    v_mfma_f32_32x32x16_bf16 v[80:95], a[28:31], v[40:43], v[80:95]
    v_sin_f32 v129, v14
    v_cos_f32 v130, v5
    v_mfma_f32_32x32x16_bf16 v[96:111], a[24:27], v[44:47], v[96:111]
    v_sin_f32 v131, v5
    v_cos_f32 v132, v6
    v_mfma_f32_32x32x16_bf16 v[112:127], a[28:31], v[44:47], v[112:127]
    buffer_load_dwordx4 v[24:27], v59, s[36:39], s58 offen offset:2048 sc1
    buffer_load_dwordx4 v[28:31], v60, s[36:39], s58 offen offset:2048 sc1
    s_add_u32 s58, s58, 4096
    s_cmp_eq_u32 s58, s59
    s_cselect_b32 s58, s57, s58
    s_waitcnt vmcnt(16)
    v_mfma_f32_32x32x16_bf16 v[64:79], a[32:35], v[48:51], v[64:79]
    ds_read_b64_tr_b16 a[184:185], v243 offset:6144
    ds_read_b64_tr_b16 a[186:187], v243 offset:7168
    ds_read_b64_tr_b16 a[188:189], v244 offset:6144
    ds_read_b64_tr_b16 a[190:191], v244 offset:7168
    v_mfma_f32_32x32x16_bf16 v[80:95], a[36:39], v[48:51], v[80:95]
    v_sin_f32 v133, v6
    v_cos_f32 v134, v7
    v_mfma_f32_32x32x16_bf16 v[96:111], a[32:35], v[52:55], v[96:111]
    v_sin_f32 v135, v7
    v_cvt_pk_bf16_f32 v232, v128, v129
    v_cvt_pk_bf16_f32 v233, v130, v131
    v_mfma_f32_32x32x16_bf16 v[112:127], a[36:39], v[52:55], v[112:127]
    buffer_load_dwordx4 v[32:35], v59, s[36:39], s58 offen offset:0 sc1
    buffer_load_dwordx4 v[36:39], v60, s[36:39], s58 offen offset:0 sc1
    s_waitcnt vmcnt(16)
    v_mfma_f32_32x32x16_bf16 v[64:79], a[40:43], v[192:195], v[64:79]
    ds_read_b64_tr_b16 a[192:193], v241 offset:0
    ds_read_b64_tr_b16 a[194:195], v241 offset:1024
    ds_read_b64_tr_b16 a[196:197], v242 offset:0
    ds_read_b64_tr_b16 a[198:199], v242 offset:1024
    v_mfma_f32_32x32x16_bf16 v[80:95], a[44:47], v[192:195], v[80:95]
    v_cvt_pk_bf16_f32 v234, v132, v133
    v_cvt_pk_bf16_f32 v235, v134, v135
    v_accvgpr_write_b32 a224, v232
    v_accvgpr_write_b32 a225, v233
    v_mfma_f32_32x32x16_bf16 v[96:111], a[40:43], v[196:199], v[96:111]
    v_accvgpr_write_b32 a226, v234
    v_accvgpr_write_b32 a227, v235
    v_add_f32 v14, v14, v13
    v_add_f32 v5, v14, v15
    v_mfma_f32_32x32x16_bf16 v[112:127], a[44:47], v[196:199], v[112:127]
    buffer_load_dwordx4 v[40:43], v59, s[36:39], s58 offen offset:2048 sc1
    buffer_load_dwordx4 v[44:47], v60, s[36:39], s58 offen offset:2048 sc1
    s_add_u32 s58, s58, 4096
    s_cmp_eq_u32 s58, s59
    s_cselect_b32 s58, s57, s58
    s_waitcnt vmcnt(16)
    v_mfma_f32_32x32x16_bf16 v[64:79], a[48:51], v[200:203], v[64:79]
    ds_read_b64_tr_b16 a[200:201], v241 offset:2048
    ds_read_b64_tr_b16 a[202:203], v241 offset:3072
    ds_read_b64_tr_b16 a[204:205], v242 offset:2048
    ds_read_b64_tr_b16 a[206:207], v242 offset:3072
    v_mfma_f32_32x32x16_bf16 v[80:95], a[52:55], v[200:203], v[80:95]
    v_sub_f32 v6, v15, v14
    v_add_f32 v7, v6, v15
    v_cos_f32 v128, v14
    v_mfma_f32_32x32x16_bf16 v[96:111], a[48:51], v[204:207], v[96:111]
    v_sin_f32 v129, v14
    v_cos_f32 v130, v5
    v_mfma_f32_32x32x16_bf16 v[112:127], a[52:55], v[204:207], v[112:127]
    buffer_load_dwordx4 v[48:51], v59, s[36:39], s58 offen offset:0 sc1
    buffer_load_dwordx4 v[52:55], v60, s[36:39], s58 offen offset:0 sc1
    s_waitcnt vmcnt(16)
    v_mfma_f32_32x32x16_bf16 v[64:79], a[56:59], v[208:211], v[64:79]
    ds_read_b64_tr_b16 a[208:209], v241 offset:4096
    ds_read_b64_tr_b16 a[210:211], v241 offset:5120
    ds_read_b64_tr_b16 a[212:213], v242 offset:4096
    ds_read_b64_tr_b16 a[214:215], v242 offset:5120
    v_mfma_f32_32x32x16_bf16 v[80:95], a[60:63], v[208:211], v[80:95]
    v_sin_f32 v131, v5
    v_cos_f32 v132, v6
    v_mfma_f32_32x32x16_bf16 v[96:111], a[56:59], v[212:215], v[96:111]
    v_sin_f32 v133, v6
    v_cos_f32 v134, v7
    v_mfma_f32_32x32x16_bf16 v[112:127], a[60:63], v[212:215], v[112:127]
    buffer_load_dwordx4 v[192:195], v59, s[36:39], s58 offen offset:2048 sc1
    buffer_load_dwordx4 v[196:199], v60, s[36:39], s58 offen offset:2048 sc1
    s_add_u32 s58, s58, 4096
    s_cmp_eq_u32 s58, s59
    s_cselect_b32 s58, s57, s58
    s_waitcnt vmcnt(16)
    v_mfma_f32_32x32x16_bf16 v[64:79], a[64:67], v[216:219], v[64:79]
    ds_read_b64_tr_b16 a[216:217], v241 offset:6144
    ds_read_b64_tr_b16 a[218:219], v241 offset:7168
    ds_read_b64_tr_b16 a[220:221], v242 offset:6144
    ds_read_b64_tr_b16 a[222:223], v242 offset:7168
    v_mfma_f32_32x32x16_bf16 v[80:95], a[68:71], v[216:219], v[80:95]
    v_sin_f32 v135, v7
    v_cvt_pk_bf16_f32 v232, v128, v129
    v_cvt_pk_bf16_f32 v233, v130, v131
    v_mfma_f32_32x32x16_bf16 v[96:111], a[64:67], v[220:223], v[96:111]
    v_cvt_pk_bf16_f32 v234, v132, v133
    v_cvt_pk_bf16_f32 v235, v134, v135
    v_accvgpr_write_b32 a228, v232
    v_accvgpr_write_b32 a229, v233
    v_mfma_f32_32x32x16_bf16 v[112:127], a[68:71], v[220:223], v[112:127]
    buffer_load_dwordx4 v[200:203], v59, s[36:39], s58 offen offset:0 sc1
    buffer_load_dwordx4 v[204:207], v60, s[36:39], s58 offen offset:0 sc1
    s_waitcnt vmcnt(16)
    v_mfma_f32_32x32x16_bf16 v[64:79], a[72:75], v[224:227], v[64:79]
    v_accvgpr_write_b32 a230, v234
    v_accvgpr_write_b32 a231, v235
    v_add_f32 v14, v14, v13
    v_add_f32 v5, v14, v15
    v_mfma_f32_32x32x16_bf16 v[80:95], a[76:79], v[224:227], v[80:95]
    v_sub_f32 v6, v15, v14
    v_add_f32 v7, v6, v15
    v_cos_f32 v128, v14
    v_mfma_f32_32x32x16_bf16 v[96:111], a[72:75], v[228:231], v[96:111]
    v_sin_f32 v129, v14
    v_cos_f32 v130, v5
    v_mfma_f32_32x32x16_bf16 v[112:127], a[76:79], v[228:231], v[112:127]
    buffer_load_dwordx4 v[208:211], v59, s[36:39], s58 offen offset:2048 sc1
    buffer_load_dwordx4 v[212:215], v60, s[36:39], s58 offen offset:2048 sc1
    s_add_u32 s58, s58, 4096
    s_cmp_eq_u32 s58, s59
    s_cselect_b32 s58, s57, s58
    s_waitcnt vmcnt(16)
    v_mfma_f32_32x32x16_bf16 v[64:79], a[80:83], v[16:19], v[64:79]
    v_sin_f32 v131, v5
    v_cos_f32 v132, v6
    v_mfma_f32_32x32x16_bf16 v[80:95], a[84:87], v[16:19], v[80:95]
    v_sin_f32 v133, v6
    v_cos_f32 v134, v7
    v_mfma_f32_32x32x16_bf16 v[96:111], a[80:83], v[20:23], v[96:111]
    v_sin_f32 v135, v7
    v_cvt_pk_bf16_f32 v232, v128, v129
    v_cvt_pk_bf16_f32 v233, v130, v131
    v_mfma_f32_32x32x16_bf16 v[112:127], a[84:87], v[20:23], v[112:127]
    buffer_load_dwordx4 v[216:219], v59, s[36:39], s58 offen offset:0 sc1
    buffer_load_dwordx4 v[220:223], v60, s[36:39], s58 offen offset:0 sc1
    s_waitcnt vmcnt(14)
    v_mfma_f32_32x32x16_bf16 v[64:79], a[88:91], v[24:27], v[64:79]
    v_cvt_pk_bf16_f32 v234, v132, v133
    v_cvt_pk_bf16_f32 v235, v134, v135
    v_accvgpr_write_b32 a232, v232
    v_accvgpr_write_b32 a233, v233
    v_mfma_f32_32x32x16_bf16 v[80:95], a[92:95], v[24:27], v[80:95]
    v_accvgpr_write_b32 a234, v234
    v_accvgpr_write_b32 a235, v235
    v_add_f32 v14, v14, v13
    v_add_f32 v5, v14, v15
    v_mfma_f32_32x32x16_bf16 v[96:111], a[88:91], v[28:31], v[96:111]
    v_sub_f32 v6, v15, v14
    v_add_f32 v7, v6, v15
    v_cos_f32 v128, v14
    v_mfma_f32_32x32x16_bf16 v[112:127], a[92:95], v[28:31], v[112:127]
    buffer_load_dwordx4 v[224:227], v59, s[36:39], s58 offen offset:2048 sc1
    buffer_load_dwordx4 v[228:231], v60, s[36:39], s58 offen offset:2048 sc1
    s_add_u32 s58, s58, 4096
    s_cmp_eq_u32 s58, s59
    s_cselect_b32 s58, s57, s58
    buffer_load_dword v176, v9, s[40:43], 0 offen sc1
    s_waitcnt vmcnt(15)
    v_mfma_f32_32x32x16_bf16 v[64:79], a[96:99], v[32:35], v[64:79]
    v_sin_f32 v129, v14
    v_cos_f32 v130, v5
    v_mfma_f32_32x32x16_bf16 v[80:95], a[100:103], v[32:35], v[80:95]
    v_sin_f32 v131, v5
    v_cos_f32 v132, v6
    v_mfma_f32_32x32x16_bf16 v[96:111], a[96:99], v[36:39], v[96:111]
    v_sin_f32 v133, v6
    v_cos_f32 v134, v7
    v_mfma_f32_32x32x16_bf16 v[112:127], a[100:103], v[36:39], v[112:127]
    buffer_load_dwordx4 v[16:19], v59, s[36:39], s58 offen offset:0 sc1
    buffer_load_dwordx4 v[20:23], v60, s[36:39], s58 offen offset:0 sc1
    s_waitcnt vmcnt(15)
    v_mfma_f32_32x32x16_bf16 v[64:79], a[104:107], v[40:43], v[64:79]
    v_sin_f32 v135, v7
    v_cvt_pk_bf16_f32 v232, v128, v129
    v_cvt_pk_bf16_f32 v233, v130, v131
    v_mfma_f32_32x32x16_bf16 v[80:95], a[108:111], v[40:43], v[80:95]
    v_cvt_pk_bf16_f32 v234, v132, v133
    v_cvt_pk_bf16_f32 v235, v134, v135
    v_accvgpr_write_b32 a236, v232
    v_accvgpr_write_b32 a237, v233
    v_mfma_f32_32x32x16_bf16 v[96:111], a[104:107], v[44:47], v[96:111]
    v_accvgpr_write_b32 a238, v234
    v_accvgpr_write_b32 a239, v235
    v_add_f32 v14, v14, v13
    v_add_f32 v5, v14, v15
    v_mfma_f32_32x32x16_bf16 v[112:127], a[108:111], v[44:47], v[112:127]
    buffer_load_dwordx4 v[24:27], v59, s[36:39], s58 offen offset:2048 sc1
    buffer_load_dwordx4 v[28:31], v60, s[36:39], s58 offen offset:2048 sc1
    s_add_u32 s58, s58, 4096
    s_cmp_eq_u32 s58, s59
    s_cselect_b32 s58, s57, s58
    s_waitcnt vmcnt(15)
    v_mfma_f32_32x32x16_bf16 v[64:79], a[112:115], v[48:51], v[64:79]
    v_sub_f32 v6, v15, v14
    v_add_f32 v7, v6, v15
    v_cos_f32 v128, v14
    v_mfma_f32_32x32x16_bf16 v[80:95], a[116:119], v[48:51], v[80:95]
    v_sin_f32 v129, v14
    v_cos_f32 v130, v5
    v_mfma_f32_32x32x16_bf16 v[96:111], a[112:115], v[52:55], v[96:111]
    v_sin_f32 v131, v5
    v_cos_f32 v132, v6
    v_mfma_f32_32x32x16_bf16 v[112:127], a[116:119], v[52:55], v[112:127]
    buffer_load_dwordx4 v[32:35], v59, s[36:39], s58 offen offset:0 sc1
    buffer_load_dwordx4 v[36:39], v60, s[36:39], s58 offen offset:0 sc1
    s_waitcnt vmcnt(15)
    v_mfma_f32_32x32x16_bf16 v[64:79], a[120:123], v[192:195], v[64:79]
    v_sin_f32 v133, v6
    v_cos_f32 v134, v7
    v_mfma_f32_32x32x16_bf16 v[80:95], a[124:127], v[192:195], v[80:95]
    v_sin_f32 v135, v7
    v_cvt_pk_bf16_f32 v232, v128, v129
    v_cvt_pk_bf16_f32 v233, v130, v131
    v_mfma_f32_32x32x16_bf16 v[96:111], a[120:123], v[196:199], v[96:111]
    v_cvt_pk_bf16_f32 v234, v132, v133
    v_cvt_pk_bf16_f32 v235, v134, v135
    v_accvgpr_write_b32 a240, v232
    v_accvgpr_write_b32 a241, v233
    v_mfma_f32_32x32x16_bf16 v[112:127], a[124:127], v[196:199], v[112:127]
    buffer_load_dwordx4 v[40:43], v59, s[36:39], s58 offen offset:2048 sc1
    buffer_load_dwordx4 v[44:47], v60, s[36:39], s58 offen offset:2048 sc1
    s_add_u32 s58, s58, 4096
    s_cmp_eq_u32 s58, s59
    s_cselect_b32 s58, s57, s58
    s_waitcnt vmcnt(15)
    s_waitcnt lgkmcnt(0)
    v_mfma_f32_32x32x16_bf16 v[64:79], a[128:131], v[200:203], v[64:79]
    v_accvgpr_write_b32 a242, v234
    v_accvgpr_write_b32 a243, v235
    v_add_f32 v14, v14, v13
    v_add_f32 v5, v14, v15
    v_mfma_f32_32x32x16_bf16 v[80:95], a[132:135], v[200:203], v[80:95]
    v_sub_f32 v6, v15, v14
    v_add_f32 v7, v6, v15
    v_cos_f32 v128, v14
    v_mfma_f32_32x32x16_bf16 v[96:111], a[128:131], v[204:207], v[96:111]
    v_sin_f32 v129, v14
    v_cos_f32 v130, v5
    v_mfma_f32_32x32x16_bf16 v[112:127], a[132:135], v[204:207], v[112:127]
    buffer_load_dwordx4 v[48:51], v59, s[36:39], s58 offen offset:0 sc1
    buffer_load_dwordx4 v[52:55], v60, s[36:39], s58 offen offset:0 sc1
    s_waitcnt vmcnt(15)
    v_mfma_f32_32x32x16_bf16 v[64:79], a[136:139], v[208:211], v[64:79]
    v_sin_f32 v131, v5
    v_cos_f32 v132, v6
    v_mfma_f32_32x32x16_bf16 v[80:95], a[140:143], v[208:211], v[80:95]
    v_sin_f32 v133, v6
    v_cos_f32 v134, v7
    v_mfma_f32_32x32x16_bf16 v[96:111], a[136:139], v[212:215], v[96:111]
    v_sin_f32 v135, v7
    v_cvt_pk_bf16_f32 v232, v128, v129
    v_cvt_pk_bf16_f32 v233, v130, v131
    v_mfma_f32_32x32x16_bf16 v[112:127], a[140:143], v[212:215], v[112:127]
    buffer_load_dwordx4 v[192:195], v59, s[36:39], s58 offen offset:2048 sc1
    buffer_load_dwordx4 v[196:199], v60, s[36:39], s58 offen offset:2048 sc1
    s_add_u32 s58, s58, 4096
    s_cmp_eq_u32 s58, s59
    s_cselect_b32 s58, s57, s58
    s_waitcnt vmcnt(15)
    v_mfma_f32_32x32x16_bf16 v[64:79], a[144:147], v[216:219], v[64:79]
    v_cvt_pk_bf16_f32 v234, v132, v133
    v_cvt_pk_bf16_f32 v235, v134, v135
    v_accvgpr_write_b32 a244, v232
    v_accvgpr_write_b32 a245, v233
    v_mfma_f32_32x32x16_bf16 v[80:95], a[148:151], v[216:219], v[80:95]
    v_accvgpr_write_b32 a246, v234
    v_accvgpr_write_b32 a247, v235
    v_add_f32 v14, v14, v13
    v_add_f32 v5, v14, v15
    v_mfma_f32_32x32x16_bf16 v[96:111], a[144:147], v[220:223], v[96:111]
    v_sub_f32 v6, v15, v14
    v_add_f32 v7, v6, v15
    v_cos_f32 v128, v14
    v_mfma_f32_32x32x16_bf16 v[112:127], a[148:151], v[220:223], v[112:127]
    buffer_load_dwordx4 v[200:203], v59, s[36:39], s58 offen offset:0 sc1
    buffer_load_dwordx4 v[204:207], v60, s[36:39], s58 offen offset:0 sc1
    s_waitcnt vmcnt(15)
    v_mfma_f32_32x32x16_bf16 v[64:79], a[152:155], v[224:227], v[64:79]
    v_sin_f32 v129, v14
    v_cos_f32 v130, v5
    v_mfma_f32_32x32x16_bf16 v[80:95], a[156:159], v[224:227], v[80:95]
    v_sin_f32 v131, v5
    v_cos_f32 v132, v6
    v_mfma_f32_32x32x16_bf16 v[96:111], a[152:155], v[228:231], v[96:111]
    v_sin_f32 v133, v6
    v_cos_f32 v134, v7
    v_mfma_f32_32x32x16_bf16 v[112:127], a[156:159], v[228:231], v[112:127]
    buffer_load_dwordx4 v[208:211], v59, s[36:39], s58 offen offset:2048 sc1
    buffer_load_dwordx4 v[212:215], v60, s[36:39], s58 offen offset:2048 sc1
    s_waitcnt vmcnt(14)
    v_mfma_f32_32x32x16_bf16 v[64:79], a[160:163], v[16:19], v[64:79]
    v_sin_f32 v135, v7
    v_cvt_pk_bf16_f32 v232, v128, v129
    v_cvt_pk_bf16_f32 v233, v130, v131
    v_mfma_f32_32x32x16_bf16 v[80:95], a[164:167], v[16:19], v[80:95]
    v_cvt_pk_bf16_f32 v234, v132, v133
    v_cvt_pk_bf16_f32 v235, v134, v135
    v_accvgpr_write_b32 a248, v232
    v_accvgpr_write_b32 a249, v233
    v_mfma_f32_32x32x16_bf16 v[96:111], a[160:163], v[20:23], v[96:111]
    v_accvgpr_write_b32 a250, v234
    v_accvgpr_write_b32 a251, v235
    v_add_f32 v14, v14, v13
    v_add_f32 v5, v14, v15
    v_mfma_f32_32x32x16_bf16 v[112:127], a[164:167], v[20:23], v[112:127]
L_chk_m:
    v_cmp_ne_u32 vcc, s47, v176
    s_cbranch_vccnz L_uslow_m
L_allset_m:
    s_waitcnt vmcnt(12)
    v_mfma_f32_32x32x16_bf16 v[64:79], a[168:171], v[24:27], v[64:79]
    v_sub_f32 v6, v15, v14
    v_add_f32 v7, v6, v15
    v_cos_f32 v128, v14
    v_mfma_f32_32x32x16_bf16 v[80:95], a[172:175], v[24:27], v[80:95]
    v_sin_f32 v129, v14
    v_cos_f32 v130, v5
    s_add_u32 s53, s62, 0
    buffer_load_dwordx4 v[144:147], v61, s[32:35], s53 offen sc1
    v_mfma_f32_32x32x16_bf16 v[96:111], a[168:171], v[28:31], v[96:111]
    v_sin_f32 v131, v5
    v_cos_f32 v132, v6
    v_mfma_f32_32x32x16_bf16 v[112:127], a[172:175], v[28:31], v[112:127]
    s_add_u32 s53, s62, 8192
    buffer_load_dwordx4 v[148:151], v61, s[32:35], s53 offen sc1
    s_waitcnt vmcnt(12)
    v_mfma_f32_32x32x16_bf16 v[64:79], a[176:179], v[32:35], v[64:79]
    v_sin_f32 v133, v6
    v_cos_f32 v134, v7
    v_mfma_f32_32x32x16_bf16 v[80:95], a[180:183], v[32:35], v[80:95]
    v_sin_f32 v135, v7
    v_cvt_pk_bf16_f32 v232, v128, v129
    v_cvt_pk_bf16_f32 v233, v130, v131
    s_add_u32 s53, s62, 16384
    buffer_load_dwordx4 v[152:155], v61, s[32:35], s53 offen sc1
    v_mfma_f32_32x32x16_bf16 v[96:111], a[176:179], v[36:39], v[96:111]
    v_cvt_pk_bf16_f32 v234, v132, v133
    v_cvt_pk_bf16_f32 v235, v134, v135
    v_accvgpr_write_b32 a252, v232
    v_accvgpr_write_b32 a253, v233
    v_mfma_f32_32x32x16_bf16 v[112:127], a[180:183], v[36:39], v[112:127]
    s_add_u32 s53, s62, 24576
    buffer_load_dwordx4 v[156:159], v61, s[32:35], s53 offen sc1
    ds_read_b64 v[246:247], v236
    ds_read_b64 v[248:249], v237
    ds_read_b64 v[250:251], v238
    ds_read_b64 v[252:253], v239
    s_waitcnt vmcnt(12)
    v_mfma_f32_32x32x16_bf16 v[64:79], a[184:187], v[40:43], v[64:79]
    v_accvgpr_write_b32 a254, v234
    v_accvgpr_write_b32 a255, v235
    v_mfma_f32_32x32x16_bf16 v[80:95], a[188:191], v[40:43], v[80:95]
    s_add_u32 s53, s62, 32768
    buffer_load_dwordx4 v[160:163], v61, s[32:35], s53 offen sc1
    v_mfma_f32_32x32x16_bf16 v[96:111], a[184:187], v[44:47], v[96:111]
    v_mfma_f32_32x32x16_bf16 v[112:127], a[188:191], v[44:47], v[112:127]
    s_add_u32 s53, s62, 40960
    buffer_load_dwordx4 v[164:167], v61, s[32:35], s53 offen sc1
    s_waitcnt vmcnt(12)
    v_mfma_f32_32x32x16_bf16 v[64:79], a[192:195], v[48:51], v[64:79]
    v_mfma_f32_32x32x16_bf16 v[80:95], a[196:199], v[48:51], v[80:95]
    s_add_u32 s53, s62, 49152
    buffer_load_dwordx4 v[168:171], v61, s[32:35], s53 offen sc1
    v_mfma_f32_32x32x16_bf16 v[96:111], a[192:195], v[52:55], v[96:111]
    v_mfma_f32_32x32x16_bf16 v[112:127], a[196:199], v[52:55], v[112:127]
    s_add_u32 s53, s62, 57344
    buffer_load_dwordx4 v[172:175], v61, s[32:35], s53 offen sc1
    s_waitcnt vmcnt(12)
    v_mfma_f32_32x32x16_bf16 v[112:127], a[204:207], v[196:199], v[112:127]
    s_mov_b32 s63, 0xffff0000
    s_waitcnt vmcnt(10)
    v_mfma_f32_32x32x16_bf16 v[112:127], a[212:215], v[204:207], v[112:127]
    s_waitcnt vmcnt(8)
    v_mfma_f32_32x32x16_bf16 v[112:127], a[220:223], v[212:215], v[112:127]
    s_waitcnt lgkmcnt(0)
    v_lshlrev_b32 v176, 16, v246
    v_and_b32 v177, s63, v246
    v_lshlrev_b32 v178, 16, v247
    v_mfma_f32_32x32x16_bf16 v[96:111], a[200:203], v[196:199], v[96:111]
    v_and_b32 v179, s63, v247
    v_lshlrev_b32 v180, 16, v248
    v_and_b32 v181, s63, v248
    v_lshlrev_b32 v182, 16, v249
    v_and_b32 v183, s63, v249
    v_mfma_f32_32x32x16_bf16 v[96:111], a[208:211], v[204:207], v[96:111]
    v_lshlrev_b32 v184, 16, v250
    v_and_b32 v185, s63, v250
    v_lshlrev_b32 v186, 16, v251
    v_and_b32 v187, s63, v251
    v_mfma_f32_32x32x16_bf16 v[96:111], a[216:219], v[212:215], v[96:111]
    v_lshlrev_b32 v188, 16, v252
    v_and_b32 v189, s63, v252
    v_lshlrev_b32 v190, 16, v253
    v_and_b32 v191, s63, v253
    v_mfma_f32_32x32x16_bf16 v[80:95], a[204:207], v[192:195], v[80:95]
    ds_write_b128 v12, v[112:115] offset:0
    ds_write_b128 v12, v[116:119] offset:1024
    v_mfma_f32_32x32x16_bf16 v[80:95], a[212:215], v[200:203], v[80:95]
    ds_write_b128 v12, v[120:123] offset:2048
    ds_write_b128 v12, v[124:127] offset:3072
    v_mfma_f32_32x32x16_bf16 v[80:95], a[220:223], v[208:211], v[80:95]
    s_mov_b32 s60, 0xbfb8aa3b
    s_mov_b32 s61, s60
    s_mov_b32 s62, 1.0
    s_mov_b32 s63, 1.0
    v_mfma_f32_32x32x16_bf16 v[64:79], a[200:203], v[192:195], v[64:79]
    v_mfma_f32_32x32x16_bf16 v[64:79], a[208:211], v[200:203], v[64:79]
    ds_write_b128 v11, v[96:99] offset:0
    ds_write_b128 v11, v[100:103] offset:1024
    v_mfma_f32_32x32x16_bf16 v[64:79], a[216:219], v[208:211], v[64:79]
    ds_write_b128 v11, v[104:107] offset:2048
    ds_write_b128 v11, v[108:111] offset:3072
    s_waitcnt vmcnt(0)
    v_mfma_f32_32x32x16_bf16 v[128:143], v[144:147], a[224:227], 0
    ds_write_b128 v10, v[80:83] offset:0
    ds_write_b128 v10, v[84:87] offset:1024
    v_mfma_f32_32x32x16_bf16 v[128:143], v[148:151], a[228:231], v[128:143]
    ds_write_b128 v10, v[88:91] offset:2048
    ds_write_b128 v10, v[92:95] offset:3072
    v_mfma_f32_32x32x16_bf16 v[128:143], v[152:155], a[232:235], v[128:143]
    v_lshl_add_u32 v10, v0, 4, s9
    v_lshl_add_u32 v11, v0, 4, s10
    v_lshl_add_u32 v12, v0, 4, s11
    s_waitcnt lgkmcnt(0)
    s_barrier
    v_mfma_f32_32x32x16_bf16 v[128:143], v[156:159], a[236:239], v[128:143]
    ds_read_b128 v[192:195], v10 offset:0
    ds_read_b128 v[208:211], v11 offset:0
    ds_read_b128 v[16:19], v12 offset:0
    ds_read_b128 v[196:199], v10 offset:1024
    v_mfma_f32_32x32x16_bf16 v[128:143], v[160:163], a[240:243], v[128:143]
    ds_read_b128 v[212:215], v11 offset:1024
    ds_read_b128 v[20:23], v12 offset:1024
    ds_read_b128 v[200:203], v10 offset:2048
    ds_read_b128 v[216:219], v11 offset:2048
    v_mfma_f32_32x32x16_bf16 v[128:143], v[164:167], a[244:247], v[128:143]
    ds_read_b128 v[24:27], v12 offset:2048
    ds_read_b128 v[204:207], v10 offset:3072
    ds_read_b128 v[220:223], v11 offset:3072
    ds_read_b128 v[28:31], v12 offset:3072
    v_mfma_f32_32x32x16_bf16 v[128:143], v[168:171], a[248:251], v[128:143]
    v_mfma_f32_32x32x16_bf16 v[128:143], v[172:175], a[252:255], v[128:143]
    s_lshl_b32 s1, s2, 2
    s_add_u32 s1, s1, s3
    s_cmp_eq_u32 s1, 803
    s_cbranch_scc1 L_ep0_m
L_noep0_m:
    s_waitcnt lgkmcnt(6)
    v_pk_add_f32 v[192:193], v[192:193], v[208:209]
    v_pk_add_f32 v[194:195], v[194:195], v[210:211]
    v_pk_add_f32 v[196:197], v[196:197], v[212:213]
    v_pk_add_f32 v[198:199], v[198:199], v[214:215]
    v_pk_add_f32 v[64:65], v[64:65], v[16:17]
    v_pk_add_f32 v[66:67], v[66:67], v[18:19]
    v_pk_add_f32 v[68:69], v[68:69], v[20:21]
    v_pk_add_f32 v[70:71], v[70:71], v[22:23]
    v_pk_add_f32 v[64:65], v[64:65], v[192:193]
    v_pk_add_f32 v[66:67], v[66:67], v[194:195]
    v_pk_add_f32 v[68:69], v[68:69], v[196:197]
    v_pk_add_f32 v[70:71], v[70:71], v[198:199]
    v_pk_mul_f32 v[80:81], v[64:65], s[60:61]
    v_pk_mul_f32 v[82:83], v[66:67], s[60:61]
    v_pk_mul_f32 v[84:85], v[68:69], s[60:61]
    v_pk_mul_f32 v[86:87], v[70:71], s[60:61]
    v_exp_f32 v80, v80
    v_exp_f32 v81, v81
    v_exp_f32 v82, v82
    v_exp_f32 v83, v83
    v_exp_f32 v84, v84
    v_exp_f32 v85, v85
    v_exp_f32 v86, v86
    v_exp_f32 v87, v87
    v_pk_add_f32 v[80:81], v[80:81], s[62:63]
    v_pk_add_f32 v[82:83], v[82:83], s[62:63]
    v_pk_add_f32 v[84:85], v[84:85], s[62:63]
    v_pk_add_f32 v[86:87], v[86:87], s[62:63]
    v_rcp_f32 v80, v80
    v_rcp_f32 v81, v81
    v_rcp_f32 v82, v82
    v_rcp_f32 v83, v83
    v_rcp_f32 v84, v84
    v_rcp_f32 v85, v85
    v_rcp_f32 v86, v86
    v_rcp_f32 v87, v87
    v_mul_f32 v64, v64, v128
    v_mul_f32 v65, v65, v132
    v_mul_f32 v66, v66, v129
    v_mul_f32 v67, v67, v133
    v_mul_f32 v68, v68, v130
    v_mul_f32 v69, v69, v134
    v_mul_f32 v70, v70, v131
    v_mul_f32 v71, v71, v135
    v_pk_fma_f32 v[80:81], v[80:81], v[64:65], v[176:177]
    v_pk_fma_f32 v[82:83], v[82:83], v[66:67], v[178:179]
    v_pk_fma_f32 v[84:85], v[84:85], v[68:69], v[180:181]
    v_pk_fma_f32 v[86:87], v[86:87], v[70:71], v[182:183]
    v_cvt_pk_bf16_f32 v96, v80, v81
    v_cvt_pk_bf16_f32 v97, v82, v83
    v_cvt_pk_bf16_f32 v98, v84, v85
    v_cvt_pk_bf16_f32 v99, v86, v87
    ds_write_b64 v236, v[96:97]
    ds_write_b64 v237, v[98:99]
    s_waitcnt lgkmcnt(2)
    v_pk_add_f32 v[200:201], v[200:201], v[216:217]
    v_pk_add_f32 v[202:203], v[202:203], v[218:219]
    v_pk_add_f32 v[204:205], v[204:205], v[220:221]
    v_pk_add_f32 v[206:207], v[206:207], v[222:223]
    v_pk_add_f32 v[72:73], v[72:73], v[24:25]
    v_pk_add_f32 v[74:75], v[74:75], v[26:27]
    v_pk_add_f32 v[76:77], v[76:77], v[28:29]
    v_pk_add_f32 v[78:79], v[78:79], v[30:31]
    v_pk_add_f32 v[72:73], v[72:73], v[200:201]
    v_pk_add_f32 v[74:75], v[74:75], v[202:203]
    v_pk_add_f32 v[76:77], v[76:77], v[204:205]
    v_pk_add_f32 v[78:79], v[78:79], v[206:207]
    v_pk_mul_f32 v[88:89], v[72:73], s[60:61]
    v_pk_mul_f32 v[90:91], v[74:75], s[60:61]
    v_pk_mul_f32 v[92:93], v[76:77], s[60:61]
    v_pk_mul_f32 v[94:95], v[78:79], s[60:61]
    v_exp_f32 v88, v88
    v_exp_f32 v89, v89
    v_exp_f32 v90, v90
    v_exp_f32 v91, v91
    v_exp_f32 v92, v92
    v_exp_f32 v93, v93
    v_exp_f32 v94, v94
    v_exp_f32 v95, v95
    v_pk_add_f32 v[88:89], v[88:89], s[62:63]
    v_pk_add_f32 v[90:91], v[90:91], s[62:63]
    v_pk_add_f32 v[92:93], v[92:93], s[62:63]
    v_pk_add_f32 v[94:95], v[94:95], s[62:63]
    v_rcp_f32 v88, v88
    v_rcp_f32 v89, v89
    v_rcp_f32 v90, v90
    v_rcp_f32 v91, v91
    v_rcp_f32 v92, v92
    v_rcp_f32 v93, v93
    v_rcp_f32 v94, v94
    v_rcp_f32 v95, v95
    v_mul_f32 v72, v72, v136
    v_mul_f32 v73, v73, v140
    v_mul_f32 v74, v74, v137
    v_mul_f32 v75, v75, v141
    v_mul_f32 v76, v76, v138
    v_mul_f32 v77, v77, v142
    v_mul_f32 v78, v78, v139
    v_mul_f32 v79, v79, v143
    v_pk_fma_f32 v[88:89], v[88:89], v[72:73], v[184:185]
    v_pk_fma_f32 v[90:91], v[90:91], v[74:75], v[186:187]
    v_pk_fma_f32 v[92:93], v[92:93], v[76:77], v[188:189]
    v_pk_fma_f32 v[94:95], v[94:95], v[78:79], v[190:191]
    v_cvt_pk_bf16_f32 v100, v88, v89
    v_cvt_pk_bf16_f32 v101, v90, v91
    v_cvt_pk_bf16_f32 v102, v92, v93
    v_cvt_pk_bf16_f32 v103, v94, v95
    ds_write_b64 v238, v[100:101]
    ds_write_b64 v239, v[102:103]
    s_waitcnt lgkmcnt(0)
    ds_read_b128 v[104:107], v240
    ds_read_b128 v[108:111], v240 offset:1024
    s_waitcnt lgkmcnt(1)
    buffer_store_dwordx4 v[104:107], v255, s[72:75], 0 offen
    s_waitcnt lgkmcnt(0)
    buffer_store_dwordx4 v[108:111], v255, s[72:75], s55 offen
    s_cmp_eq_u32 s1, 803
    s_cbranch_scc1 L_ep1_m
L_noep_m:
    s_endpgm
L_dft:
    s_add_u32 s60, s28, 12656640
    s_addc_u32 s61, s29, 0
    s_load_dword s47, s[60:61], 0
    s_mov_b32 s36, s10
    s_mov_b32 s37, s11
    s_mov_b32 s38, 524288
    s_mov_b32 s39, 0x20000
    s_mov_b32 s16, s12
    s_mov_b32 s17, s13
    s_mov_b32 s18, 524288
    s_mov_b32 s19, 0x20000
    s_add_u32 s40, s28, 12582912
    s_addc_u32 s41, s29, 0
    s_mov_b32 s42, 4194304
    s_mov_b32 s43, 0x20000
    s_lshl_b32 s46, s48, 3
    s_lshl_b32 s53, s49, 2
    s_add_u32 s46, s46, s53
    s_add_u32 s46, s46, 65536
    v_xor_b32 v26, v26, v25
    v_lshlrev_b32 v26, 4, v26
    v_lshl_add_u32 v27, v24, 11, v26
    s_lshl_b32 s53, s3, 16
    s_lshl_b32 s54, s49, 10
    s_add_u32 s53, s53, s54
    v_add_u32 v4, s53, v27
    v_xor_b32 v28, 64, v4
    v_add_u32 v5, 15360, v28
    v_add_u32 v6, 30720, v4
    v_add_u32 v7, 46080, v28
    v_add_u32 v28, 0x40000, v4
    v_cmp_gt_u32 vcc, 1024, v4
    v_lshl_add_u32 v27, v24, 7, v26
    s_lshl_b32 s53, s3, 12
    v_cndmask_b32 v56, v4, v28, vcc
    v_add_u32 v8, s53, v27
    v_xor_b32 v9, 64, v8
    s_mul_i32 s55, s3, 24576
    s_add_u32 s55, s55, 65536
    s_lshl_b32 s53, s48, 1
    s_add_u32 s53, s53, s49
    s_lshl_b32 s53, s53, 11
    s_lshl_b32 s54, s51, 10
    s_add_u32 s53, s53, s54
    s_lshl_b32 s54, s50, 9
    s_add_u32 s53, s53, s54
    s_add_u32 s53, s53, 1048576
    v_lshl_add_u32 v3, v24, 4, s53
    s_lshl_b32 s53, s48, 1
    s_add_u32 s53, s53, s49
    s_lshl_b32 s53, s53, 9
    s_add_u32 s13, s53, 1572864
    s_lshl_b32 s54, s3, 7
    s_add_u32 s53, s13, s54
    v_lshl_add_u32 v244, v24, 2, s53
    v_and_b32 v242, 3, v0
    v_lshl_add_u32 v244, v242, 5, v244
    v_and_b32 v24, 31, v0
    v_lshrrev_b32 v25, 5, v0
    v_bfe_u32 v26, v0, 1, 3
    v_xor_b32 v26, v26, v25
    v_lshlrev_b32 v27, 7, v24
    v_xor_b32 v28, 0, v26
    v_lshl_add_u32 v10, v28, 4, v27
    v_add_u32 v14, s55, v10
    v_xor_b32 v28, 2, v26
    v_lshl_add_u32 v11, v28, 4, v27
    v_add_u32 v15, s55, v11
    v_xor_b32 v28, 4, v26
    v_lshl_add_u32 v12, v28, 4, v27
    v_add_u32 v16, s55, v12
    v_xor_b32 v28, 6, v26
    v_lshl_add_u32 v13, v28, 4, v27
    v_add_u32 v17, s55, v13
    v_cvt_f32_u32 v26, v24
    v_mul_f32 v26, 0x3d000000, v26
    v_cvt_f32_u32 v27, v25
    v_mul_f32 v27, 4.0, v27
    v_mul_f32 v27, v27, v26
    v_mul_f32 v28, 0x40a00000, v26
    v_fract_f32 v29, v27
    v_cos_f32 v20, v29
    v_sin_f32 v22, v29
    v_add_f32 v27, v27, v26
    v_fract_f32 v29, v27
    v_cos_f32 v21, v29
    v_sin_f32 v23, v29
    v_cvt_pk_bf16_f32 v192, v20, v21
    v_cvt_pk_bf16_f32 v200, v22, v23
    v_xor_b32 v208, 0x80008000, v200
    v_add_f32 v27, v27, v26
    v_fract_f32 v29, v27
    v_cos_f32 v20, v29
    v_sin_f32 v22, v29
    v_add_f32 v27, v27, v26
    v_fract_f32 v29, v27
    v_cos_f32 v21, v29
    v_sin_f32 v23, v29
    v_cvt_pk_bf16_f32 v193, v20, v21
    v_cvt_pk_bf16_f32 v201, v22, v23
    v_xor_b32 v209, 0x80008000, v201
    v_add_f32 v27, v27, v28
    v_fract_f32 v29, v27
    v_cos_f32 v20, v29
    v_sin_f32 v22, v29
    v_add_f32 v27, v27, v26
    v_fract_f32 v29, v27
    v_cos_f32 v21, v29
    v_sin_f32 v23, v29
    v_cvt_pk_bf16_f32 v194, v20, v21
    v_cvt_pk_bf16_f32 v202, v22, v23
    v_xor_b32 v210, 0x80008000, v202
    v_add_f32 v27, v27, v26
    v_fract_f32 v29, v27
    v_cos_f32 v20, v29
    v_sin_f32 v22, v29
    v_add_f32 v27, v27, v26
    v_fract_f32 v29, v27
    v_cos_f32 v21, v29
    v_sin_f32 v23, v29
    v_cvt_pk_bf16_f32 v195, v20, v21
    v_cvt_pk_bf16_f32 v203, v22, v23
    v_xor_b32 v211, 0x80008000, v203
    v_add_f32 v27, v27, v28
    v_fract_f32 v29, v27
    v_cos_f32 v20, v29
    v_sin_f32 v22, v29
    v_add_f32 v27, v27, v26
    v_fract_f32 v29, v27
    v_cos_f32 v21, v29
    v_sin_f32 v23, v29
    v_cvt_pk_bf16_f32 v196, v20, v21
    v_cvt_pk_bf16_f32 v204, v22, v23
    v_xor_b32 v212, 0x80008000, v204
    v_add_f32 v27, v27, v26
    v_fract_f32 v29, v27
    v_cos_f32 v20, v29
    v_sin_f32 v22, v29
    v_add_f32 v27, v27, v26
    v_fract_f32 v29, v27
    v_cos_f32 v21, v29
    v_sin_f32 v23, v29
    v_cvt_pk_bf16_f32 v197, v20, v21
    v_cvt_pk_bf16_f32 v205, v22, v23
    v_xor_b32 v213, 0x80008000, v205
    v_add_f32 v27, v27, v28
    v_fract_f32 v29, v27
    v_cos_f32 v20, v29
    v_sin_f32 v22, v29
    v_add_f32 v27, v27, v26
    v_fract_f32 v29, v27
    v_cos_f32 v21, v29
    v_sin_f32 v23, v29
    v_cvt_pk_bf16_f32 v198, v20, v21
    v_cvt_pk_bf16_f32 v206, v22, v23
    v_xor_b32 v214, 0x80008000, v206
    v_add_f32 v27, v27, v26
    v_fract_f32 v29, v27
    v_cos_f32 v20, v29
    v_sin_f32 v22, v29
    v_add_f32 v27, v27, v26
    v_fract_f32 v29, v27
    v_cos_f32 v21, v29
    v_sin_f32 v23, v29
    v_cvt_pk_bf16_f32 v199, v20, v21
    v_cvt_pk_bf16_f32 v207, v22, v23
    v_xor_b32 v215, 0x80008000, v207
    s_mov_b32 s59, 0x3f803f80
    s_movk_i32 s60, 0x3f80
    s_mov_b32 s61, 0x3f800000
    s_lshl_b32 s53, s49, 15
    s_or_b32 s62, s60, s53
    s_lshl_b32 s63, s62, 16
    s_cmp_eq_u32 s49, 0
    s_cselect_b32 s101, 2.0, 0
    s_waitcnt lgkmcnt(0)
    s_mul_i32 s47, s47, 0x9e3779b1
    s_add_u32 s47, s47, 0x85ebca6b
    s_waitcnt vmcnt(8)
    v_dot2_f32_bf16 v224, v64, s59, 0
    v_dot2_f32_bf16 v226, v64, v64, 0
    v_dot2_f32_bf16 v225, v65, s59, 0
    v_dot2_f32_bf16 v227, v65, v65, 0
    v_dot2c_f32_bf16 v224, s59, v66
    v_dot2c_f32_bf16 v226, v66, v66
    v_dot2c_f32_bf16 v225, s59, v67
    v_dot2c_f32_bf16 v227, v67, v67
    v_dot2c_f32_bf16 v224, s59, v68
    v_dot2c_f32_bf16 v226, v68, v68
    v_dot2c_f32_bf16 v225, s59, v69
    v_dot2c_f32_bf16 v227, v69, v69
    v_dot2c_f32_bf16 v224, s59, v70
    v_dot2c_f32_bf16 v226, v70, v70
    v_dot2c_f32_bf16 v225, s59, v71
    v_dot2c_f32_bf16 v227, v71, v71
    v_dot2c_f32_bf16 v224, s59, v72
    v_dot2c_f32_bf16 v226, v72, v72
    v_dot2c_f32_bf16 v225, s59, v73
    v_dot2c_f32_bf16 v227, v73, v73
    v_dot2c_f32_bf16 v224, s59, v74
    v_dot2c_f32_bf16 v226, v74, v74
    v_dot2c_f32_bf16 v225, s59, v75
    v_dot2c_f32_bf16 v227, v75, v75
    v_dot2c_f32_bf16 v224, s59, v76
    v_dot2c_f32_bf16 v226, v76, v76
    v_dot2c_f32_bf16 v225, s59, v77
    v_dot2c_f32_bf16 v227, v77, v77
    v_dot2c_f32_bf16 v224, s59, v78
    v_dot2c_f32_bf16 v226, v78, v78
    v_dot2c_f32_bf16 v225, s59, v79
    v_dot2c_f32_bf16 v227, v79, v79
    v_dot2c_f32_bf16 v224, s59, v80
    v_dot2c_f32_bf16 v226, v80, v80
    v_dot2c_f32_bf16 v225, s59, v81
    v_dot2c_f32_bf16 v227, v81, v81
    v_dot2c_f32_bf16 v224, s59, v82
    v_dot2c_f32_bf16 v226, v82, v82
    v_dot2c_f32_bf16 v225, s59, v83
    v_dot2c_f32_bf16 v227, v83, v83
    v_dot2c_f32_bf16 v224, s59, v84
    v_dot2c_f32_bf16 v226, v84, v84
    v_dot2c_f32_bf16 v225, s59, v85
    v_dot2c_f32_bf16 v227, v85, v85
    v_dot2c_f32_bf16 v224, s59, v86
    v_dot2c_f32_bf16 v226, v86, v86
    v_dot2c_f32_bf16 v225, s59, v87
    v_dot2c_f32_bf16 v227, v87, v87
    v_dot2c_f32_bf16 v224, s59, v88
    v_dot2c_f32_bf16 v226, v88, v88
    v_dot2c_f32_bf16 v225, s59, v89
    v_dot2c_f32_bf16 v227, v89, v89
    v_dot2c_f32_bf16 v224, s59, v90
    v_dot2c_f32_bf16 v226, v90, v90
    v_dot2c_f32_bf16 v225, s59, v91
    v_dot2c_f32_bf16 v227, v91, v91
    v_dot2c_f32_bf16 v224, s59, v92
    v_dot2c_f32_bf16 v226, v92, v92
    v_dot2c_f32_bf16 v225, s59, v93
    v_dot2c_f32_bf16 v227, v93, v93
    v_dot2c_f32_bf16 v224, s59, v94
    v_dot2c_f32_bf16 v226, v94, v94
    v_dot2c_f32_bf16 v225, s59, v95
    v_dot2c_f32_bf16 v227, v95, v95
    s_waitcnt vmcnt(0)
    v_dot2_f32_bf16 v228, v96, s59, 0
    v_dot2_f32_bf16 v230, v96, v96, 0
    v_dot2_f32_bf16 v229, v97, s59, 0
    v_dot2_f32_bf16 v231, v97, v97, 0
    v_dot2c_f32_bf16 v228, s59, v98
    v_dot2c_f32_bf16 v230, v98, v98
    v_add_f32 v224, v224, v225
    v_add_f32 v226, v226, v227
    v_dot2c_f32_bf16 v229, s59, v99
    v_dot2c_f32_bf16 v231, v99, v99
    s_mov_b32 s58, 1048576
    buffer_load_dwordx4 v[128:131], v57, s[32:35], s58 offen offset:0
    v_add_f32_dpp v224, v224, v224 quad_perm:[1,0,3,2] row_mask:0xf bank_mask:0xf
    v_add_f32_dpp v226, v226, v226 quad_perm:[1,0,3,2] row_mask:0xf bank_mask:0xf
    v_dot2c_f32_bf16 v228, s59, v100
    v_dot2c_f32_bf16 v230, v100, v100
    v_add_f32_dpp v224, v224, v224 quad_perm:[2,3,0,1] row_mask:0xf bank_mask:0xf
    v_add_f32_dpp v226, v226, v226 quad_perm:[2,3,0,1] row_mask:0xf bank_mask:0xf
    v_dot2c_f32_bf16 v229, s59, v101
    v_dot2c_f32_bf16 v231, v101, v101
    v_add_f32_dpp v224, v224, v224 row_half_mirror row_mask:0xf bank_mask:0xf
    v_add_f32_dpp v226, v226, v226 row_half_mirror row_mask:0xf bank_mask:0xf
    v_dot2c_f32_bf16 v228, s59, v102
    v_dot2c_f32_bf16 v230, v102, v102
    v_mul_f32 v20, 0xbb000000, v224
    v_mul_f32 v21, 0x3b000000, v226
    v_dot2c_f32_bf16 v229, s59, v103
    v_dot2c_f32_bf16 v231, v103, v103
    buffer_load_dwordx4 v[132:135], v18, s[32:35], s58 offen offset:0
    v_fma_f32 v21, -v20, v20, v21
    v_cvt_pk_bf16_f32 v23, v20, v20
    v_dot2c_f32_bf16 v228, s59, v104
    v_dot2c_f32_bf16 v230, v104, v104
    v_max_f32 v21, 0, v21
    v_lshlrev_b32 v23, 16, v23
    v_dot2c_f32_bf16 v229, s59, v105
    v_dot2c_f32_bf16 v231, v105, v105
    v_cvt_pk_bf16_f32 v22, 0, v21
    v_sub_f32 v23, v20, v23
    v_dot2c_f32_bf16 v228, s59, v106
    v_dot2c_f32_bf16 v230, v106, v106
    v_add_f32 v22, 0x3727c5ac, v22
    v_cvt_pk_bf16_f32 v232, v20, v23
    v_dot2c_f32_bf16 v229, s59, v107
    v_dot2c_f32_bf16 v231, v107, v107
    buffer_load_dwordx4 v[136:139], v19, s[32:35], s58 offen offset:0
    v_cvt_pk_bf16_f32 v22, 0, v22
    v_mul_f32 v217, s101, v20
    v_dot2c_f32_bf16 v228, s59, v108
    v_dot2c_f32_bf16 v230, v108, v108
    v_sqrt_f32 v22, v22
    v_mov_b32 v235, s47
    v_dot2c_f32_bf16 v229, s59, v109
    v_dot2c_f32_bf16 v231, v109, v109
    v_cvt_pk_bf16_f32 v22, 0, v22
    v_rcp_f32 v216, v22
    v_dot2c_f32_bf16 v228, s59, v110
    v_dot2c_f32_bf16 v230, v110, v110
    v_mul_f32 v23, 0xc4000000, v23
    v_mul_f32 v21, v21, v216
    v_dot2c_f32_bf16 v229, s59, v111
    v_dot2c_f32_bf16 v231, v111, v111
    buffer_load_dwordx4 v[140:143], v2, s[32:35], s58 offen offset:0
    v_mul_f32 v240, v23, v216
    v_mul_f32 v21, v21, v216
    v_dot2c_f32_bf16 v228, s59, v112
    v_dot2c_f32_bf16 v230, v112, v112
    v_cvt_pk_bf16_f32 v21, 0, v21
    v_add_f32 v21, 0x3727c5ac, v21
    v_dot2c_f32_bf16 v229, s59, v113
    v_dot2c_f32_bf16 v231, v113, v113
    v_cvt_pk_bf16_f32 v21, 0, v21
    v_sqrt_f32 v21, v21
    v_dot2c_f32_bf16 v228, s59, v114
    v_dot2c_f32_bf16 v230, v114, v114
    v_cvt_pk_bf16_f32 v21, 0, v21
    v_mul_f32 v234, v21, v22
    v_dot2c_f32_bf16 v229, s59, v115
    v_dot2c_f32_bf16 v231, v115, v115
    buffer_load_dwordx4 v[144:147], v57, s[32:35], s58 offen offset:512
    v_cvt_pk_bf16_f32 v21, 0, v234
    v_sub_f32 v21, v234, v21
    v_dot2c_f32_bf16 v228, s59, v116
    v_dot2c_f32_bf16 v230, v116, v116
    v_cvt_pk_bf16_f32 v233, v234, v21
    buffer_store_dwordx4 v[232:235], v3, s[40:43], 0 offen offset:0 sc1
    v_dot2c_f32_bf16 v229, s59, v117
    v_dot2c_f32_bf16 v231, v117, v117
    v_dot2c_f32_bf16 v228, s59, v118
    v_dot2c_f32_bf16 v230, v118, v118
    v_dot2c_f32_bf16 v229, s59, v119
    v_dot2c_f32_bf16 v231, v119, v119
    buffer_load_dwordx4 v[148:151], v18, s[32:35], s58 offen offset:512
    v_dot2c_f32_bf16 v228, s59, v120
    v_dot2c_f32_bf16 v230, v120, v120
    v_dot2c_f32_bf16 v229, s59, v121
    v_dot2c_f32_bf16 v231, v121, v121
    v_dot2c_f32_bf16 v228, s59, v122
    v_dot2c_f32_bf16 v230, v122, v122
    v_dot2c_f32_bf16 v229, s59, v123
    v_dot2c_f32_bf16 v231, v123, v123
    buffer_load_dwordx4 v[152:155], v19, s[32:35], s58 offen offset:512
    v_dot2c_f32_bf16 v228, s59, v124
    v_dot2c_f32_bf16 v230, v124, v124
    v_dot2c_f32_bf16 v229, s59, v125
    v_dot2c_f32_bf16 v231, v125, v125
    v_dot2c_f32_bf16 v228, s59, v126
    v_dot2c_f32_bf16 v230, v126, v126
    v_dot2c_f32_bf16 v229, s59, v127
    v_dot2c_f32_bf16 v231, v127, v127
    buffer_load_dwordx4 v[156:159], v2, s[32:35], s58 offen offset:512
    v_dot2_f32_bf16 v40, v64, s60, v217
    v_dot2_f32_bf16 v41, v64, s61, v217
    v_add_f32 v228, v228, v229
    v_dot2_f32_bf16 v42, v65, s60, v217
    v_dot2_f32_bf16 v43, v65, s61, v217
    v_add_f32 v230, v230, v231
    v_dot2_f32_bf16 v44, v66, s60, v217
    v_dot2_f32_bf16 v45, v66, s61, v217
    v_add_f32_dpp v228, v228, v228 quad_perm:[1,0,3,2] row_mask:0xf bank_mask:0xf
    v_dot2_f32_bf16 v46, v67, s60, v217
    v_dot2_f32_bf16 v47, v67, s61, v217
    v_add_f32_dpp v230, v230, v230 quad_perm:[1,0,3,2] row_mask:0xf bank_mask:0xf
    s_mov_b32 s58, 1572864
    buffer_load_dwordx4 v[160:163], v57, s[32:35], s58 offen offset:0
    v_dot2c_f32_bf16 v40, s62, v80
    v_dot2c_f32_bf16 v41, s63, v80
    v_add_f32_dpp v228, v228, v228 quad_perm:[2,3,0,1] row_mask:0xf bank_mask:0xf
    v_dot2c_f32_bf16 v42, s62, v81
    v_dot2c_f32_bf16 v43, s63, v81
    v_add_f32_dpp v230, v230, v230 quad_perm:[2,3,0,1] row_mask:0xf bank_mask:0xf
    v_dot2c_f32_bf16 v44, s62, v82
    v_dot2c_f32_bf16 v45, s63, v82
    v_add_f32_dpp v228, v228, v228 row_half_mirror row_mask:0xf bank_mask:0xf
    v_dot2c_f32_bf16 v46, s62, v83
    v_dot2c_f32_bf16 v47, s63, v83
    v_add_f32_dpp v230, v230, v230 row_half_mirror row_mask:0xf bank_mask:0xf
    v_mul_f32 v20, 0xbb000000, v228
    v_mul_f32 v21, 0x3b000000, v230
    v_pk_mul_f32 v[40:41], v[40:41], v[216:217] op_sel_hi:[1,0]
    v_pk_mul_f32 v[42:43], v[42:43], v[216:217] op_sel_hi:[1,0]
    v_pk_mul_f32 v[44:45], v[44:45], v[216:217] op_sel_hi:[1,0]
    v_pk_mul_f32 v[46:47], v[46:47], v[216:217] op_sel_hi:[1,0]
    buffer_load_dwordx4 v[164:167], v18, s[32:35], s58 offen offset:0
    v_cvt_pk_bf16_f32 v24, v40, v41
    v_cvt_pk_bf16_f32 v25, v42, v43
    v_cvt_pk_bf16_f32 v26, v44, v45
    v_cvt_pk_bf16_f32 v27, v46, v47
    ds_write_b128 v8, v[24:27] offset:0
    v_dot2_f32_bf16 v48, v68, s60, v217
    v_dot2_f32_bf16 v49, v68, s61, v217
    v_fma_f32 v21, -v20, v20, v21
    v_dot2_f32_bf16 v50, v69, s60, v217
    v_dot2_f32_bf16 v51, v69, s61, v217
    v_cvt_pk_bf16_f32 v23, v20, v20
    v_dot2_f32_bf16 v52, v70, s60, v217
    v_dot2_f32_bf16 v53, v70, s61, v217
    v_max_f32 v21, 0, v21
    v_dot2_f32_bf16 v54, v71, s60, v217
    v_dot2_f32_bf16 v55, v71, s61, v217
    v_lshlrev_b32 v23, 16, v23
    buffer_load_dwordx4 v[168:171], v19, s[32:35], s58 offen offset:0
    v_dot2c_f32_bf16 v48, s62, v84
    v_dot2c_f32_bf16 v49, s63, v84
    v_cvt_pk_bf16_f32 v22, 0, v21
    v_dot2c_f32_bf16 v50, s62, v85
    v_dot2c_f32_bf16 v51, s63, v85
    v_sub_f32 v23, v20, v23
    v_dot2c_f32_bf16 v52, s62, v86
    v_dot2c_f32_bf16 v53, s63, v86
    v_add_f32 v22, 0x3727c5ac, v22
    v_dot2c_f32_bf16 v54, s62, v87
    v_dot2c_f32_bf16 v55, s63, v87
    v_cvt_pk_bf16_f32 v236, v20, v23
    v_cvt_pk_bf16_f32 v22, 0, v22
    v_mul_f32 v219, s101, v20
    v_pk_mul_f32 v[48:49], v[48:49], v[216:217] op_sel_hi:[1,0]
    v_pk_mul_f32 v[50:51], v[50:51], v[216:217] op_sel_hi:[1,0]
    v_pk_mul_f32 v[52:53], v[52:53], v[216:217] op_sel_hi:[1,0]
    v_pk_mul_f32 v[54:55], v[54:55], v[216:217] op_sel_hi:[1,0]
    buffer_load_dwordx4 v[172:175], v2, s[32:35], s58 offen offset:0
    v_cvt_pk_bf16_f32 v28, v48, v49
    v_cvt_pk_bf16_f32 v29, v50, v51
    v_cvt_pk_bf16_f32 v30, v52, v53
    v_cvt_pk_bf16_f32 v31, v54, v55
    ds_write_b128 v8, v[28:31] offset:16384
    v_dot2_f32_bf16 v40, v72, s60, v217
    v_dot2_f32_bf16 v41, v72, s61, v217
    v_sqrt_f32 v22, v22
    v_dot2_f32_bf16 v42, v73, s60, v217
    v_dot2_f32_bf16 v43, v73, s61, v217
    v_mov_b32 v239, s47
    v_dot2_f32_bf16 v44, v74, s60, v217
    v_dot2_f32_bf16 v45, v74, s61, v217
    v_cvt_pk_bf16_f32 v22, 0, v22
    v_dot2_f32_bf16 v46, v75, s60, v217
    v_dot2_f32_bf16 v47, v75, s61, v217
    v_rcp_f32 v218, v22
    buffer_load_dwordx4 v[176:179], v57, s[32:35], s58 offen offset:512
    v_dot2c_f32_bf16 v40, s62, v88
    v_dot2c_f32_bf16 v41, s63, v88
    v_mul_f32 v23, 0xc4000000, v23
    v_dot2c_f32_bf16 v42, s62, v89
    v_dot2c_f32_bf16 v43, s63, v89
    v_mul_f32 v21, v21, v218
    v_dot2c_f32_bf16 v44, s62, v90
    v_dot2c_f32_bf16 v45, s63, v90
    v_mul_f32 v241, v23, v218
    v_dot2c_f32_bf16 v46, s62, v91
    v_dot2c_f32_bf16 v47, s63, v91
    v_mul_f32 v21, v21, v218
    v_cvt_pk_bf16_f32 v21, 0, v21
    v_add_f32 v21, 0x3727c5ac, v21
    v_pk_mul_f32 v[40:41], v[40:41], v[216:217] op_sel_hi:[1,0]
    v_pk_mul_f32 v[42:43], v[42:43], v[216:217] op_sel_hi:[1,0]
    v_pk_mul_f32 v[44:45], v[44:45], v[216:217] op_sel_hi:[1,0]
    v_pk_mul_f32 v[46:47], v[46:47], v[216:217] op_sel_hi:[1,0]
    buffer_load_dwordx4 v[180:183], v18, s[32:35], s58 offen offset:512
    v_cvt_pk_bf16_f32 v24, v40, v41
    v_cvt_pk_bf16_f32 v25, v42, v43
    v_cvt_pk_bf16_f32 v26, v44, v45
    v_cvt_pk_bf16_f32 v27, v46, v47
    ds_write_b128 v8, v[24:27] offset:32768
    v_dot2_f32_bf16 v48, v76, s60, v217
    v_dot2_f32_bf16 v49, v76, s61, v217
    v_cvt_pk_bf16_f32 v21, 0, v21
    v_dot2_f32_bf16 v50, v77, s60, v217
    v_dot2_f32_bf16 v51, v77, s61, v217
    v_sqrt_f32 v21, v21
    v_dot2_f32_bf16 v52, v78, s60, v217
    v_dot2_f32_bf16 v53, v78, s61, v217
    v_cvt_pk_bf16_f32 v21, 0, v21
    v_dot2_f32_bf16 v54, v79, s60, v217
    v_dot2_f32_bf16 v55, v79, s61, v217
    v_mul_f32 v238, v21, v22
    buffer_load_dwordx4 v[184:187], v19, s[32:35], s58 offen offset:512
    v_dot2c_f32_bf16 v48, s62, v92
    v_dot2c_f32_bf16 v49, s63, v92
    v_cvt_pk_bf16_f32 v21, 0, v238
    v_dot2c_f32_bf16 v50, s62, v93
    v_dot2c_f32_bf16 v51, s63, v93
    v_sub_f32 v21, v238, v21
    v_dot2c_f32_bf16 v52, s62, v94
    v_dot2c_f32_bf16 v53, s63, v94
    v_cvt_pk_bf16_f32 v237, v238, v21
    v_dot2c_f32_bf16 v54, s62, v95
    v_dot2c_f32_bf16 v55, s63, v95
    buffer_store_dwordx4 v[236:239], v3, s[40:43], 0 offen offset:128 sc1
    v_cmp_eq_u32 vcc, 1, v242
    s_nop 1
    v_cndmask_b32 v240, v240, v241, vcc
    v_pk_mul_f32 v[48:49], v[48:49], v[216:217] op_sel_hi:[1,0]
    v_pk_mul_f32 v[50:51], v[50:51], v[216:217] op_sel_hi:[1,0]
    v_pk_mul_f32 v[52:53], v[52:53], v[216:217] op_sel_hi:[1,0]
    v_pk_mul_f32 v[54:55], v[54:55], v[216:217] op_sel_hi:[1,0]
    buffer_load_dwordx4 v[188:191], v2, s[32:35], s58 offen offset:512
    v_cvt_pk_bf16_f32 v28, v48, v49
    v_cvt_pk_bf16_f32 v29, v50, v51
    v_cvt_pk_bf16_f32 v30, v52, v53
    v_cvt_pk_bf16_f32 v31, v54, v55
    ds_write_b128 v8, v[28:31] offset:49152
    s_waitcnt vmcnt(9)
    v_dot2_f32_bf16 v224, v128, s59, 0
    v_dot2_f32_bf16 v226, v128, v128, 0
    v_dot2_f32_bf16 v225, v129, s59, 0
    v_dot2_f32_bf16 v227, v129, v129, 0
    v_dot2c_f32_bf16 v224, s59, v130
    v_dot2c_f32_bf16 v226, v130, v130
    v_dot2c_f32_bf16 v225, s59, v131
    v_dot2c_f32_bf16 v227, v131, v131
    s_xor_b32 s57, s100, 0
    s_lshl_b32 s57, s57, 7
    s_add_u32 m0, s55, 0
    s_nop 0
    buffer_load_dwordx4 v56, s[36:39], s57 offen offset:0 lds
    v_dot2c_f32_bf16 v224, s59, v132
    v_dot2c_f32_bf16 v226, v132, v132
    v_dot2c_f32_bf16 v225, s59, v133
    v_dot2c_f32_bf16 v227, v133, v133
    v_dot2c_f32_bf16 v224, s59, v134
    v_dot2c_f32_bf16 v226, v134, v134
    v_dot2c_f32_bf16 v225, s59, v135
    v_dot2c_f32_bf16 v227, v135, v135
    buffer_load_dwordx4 v5, s[36:39], s57 offen offset:1024 lds
    v_dot2c_f32_bf16 v224, s59, v136
    v_dot2c_f32_bf16 v226, v136, v136
    v_dot2c_f32_bf16 v225, s59, v137
    v_dot2c_f32_bf16 v227, v137, v137
    v_dot2c_f32_bf16 v224, s59, v138
    v_dot2c_f32_bf16 v226, v138, v138
    v_dot2c_f32_bf16 v225, s59, v139
    v_dot2c_f32_bf16 v227, v139, v139
    buffer_load_dwordx4 v6, s[36:39], s57 offen offset:2048 lds
    v_dot2c_f32_bf16 v224, s59, v140
    v_dot2c_f32_bf16 v226, v140, v140
    v_dot2c_f32_bf16 v225, s59, v141
    v_dot2c_f32_bf16 v227, v141, v141
    v_dot2c_f32_bf16 v224, s59, v142
    v_dot2c_f32_bf16 v226, v142, v142
    v_dot2c_f32_bf16 v225, s59, v143
    v_dot2c_f32_bf16 v227, v143, v143
    buffer_load_dwordx4 v7, s[36:39], s57 offen offset:3072 lds
    v_dot2c_f32_bf16 v224, s59, v144
    v_dot2c_f32_bf16 v226, v144, v144
    v_dot2c_f32_bf16 v225, s59, v145
    v_dot2c_f32_bf16 v227, v145, v145
    v_dot2c_f32_bf16 v224, s59, v146
    v_dot2c_f32_bf16 v226, v146, v146
    v_dot2c_f32_bf16 v225, s59, v147
    v_dot2c_f32_bf16 v227, v147, v147
    s_add_u32 m0, s55, 4096
    s_nop 0
    buffer_load_dwordx4 v4, s[16:19], s57 offen offset:0 lds
    v_dot2c_f32_bf16 v224, s59, v148
    v_dot2c_f32_bf16 v226, v148, v148
    v_dot2c_f32_bf16 v225, s59, v149
    v_dot2c_f32_bf16 v227, v149, v149
    v_dot2c_f32_bf16 v224, s59, v150
    v_dot2c_f32_bf16 v226, v150, v150
    v_dot2c_f32_bf16 v225, s59, v151
    v_dot2c_f32_bf16 v227, v151, v151
    buffer_load_dwordx4 v5, s[16:19], s57 offen offset:1024 lds
    v_dot2c_f32_bf16 v224, s59, v152
    v_dot2c_f32_bf16 v226, v152, v152
    v_dot2c_f32_bf16 v225, s59, v153
    v_dot2c_f32_bf16 v227, v153, v153
    v_dot2c_f32_bf16 v224, s59, v154
    v_dot2c_f32_bf16 v226, v154, v154
    v_dot2c_f32_bf16 v225, s59, v155
    v_dot2c_f32_bf16 v227, v155, v155
    buffer_load_dwordx4 v6, s[16:19], s57 offen offset:2048 lds
    v_dot2c_f32_bf16 v224, s59, v156
    v_dot2c_f32_bf16 v226, v156, v156
    v_dot2c_f32_bf16 v225, s59, v157
    v_dot2c_f32_bf16 v227, v157, v157
    v_dot2c_f32_bf16 v224, s59, v158
    v_dot2c_f32_bf16 v226, v158, v158
    v_dot2c_f32_bf16 v225, s59, v159
    v_dot2c_f32_bf16 v227, v159, v159
    buffer_load_dwordx4 v7, s[16:19], s57 offen offset:3072 lds
    v_dot2_f32_bf16 v40, v96, s60, v219
    v_dot2_f32_bf16 v41, v96, s61, v219
    v_add_f32 v224, v224, v225
    v_dot2_f32_bf16 v42, v97, s60, v219
    v_dot2_f32_bf16 v43, v97, s61, v219
    v_add_f32 v226, v226, v227
    v_dot2_f32_bf16 v44, v98, s60, v219
    v_dot2_f32_bf16 v45, v98, s61, v219
    v_add_f32_dpp v224, v224, v224 quad_perm:[1,0,3,2] row_mask:0xf bank_mask:0xf
    v_dot2_f32_bf16 v46, v99, s60, v219
    v_dot2_f32_bf16 v47, v99, s61, v219
    v_add_f32_dpp v226, v226, v226 quad_perm:[1,0,3,2] row_mask:0xf bank_mask:0xf
    s_xor_b32 s57, s100, 1
    s_lshl_b32 s57, s57, 7
    s_add_u32 m0, s55, 8192
    s_nop 0
    buffer_load_dwordx4 v56, s[36:39], s57 offen offset:0 lds
    v_dot2c_f32_bf16 v40, s62, v112
    v_dot2c_f32_bf16 v41, s63, v112
    v_add_f32_dpp v224, v224, v224 quad_perm:[2,3,0,1] row_mask:0xf bank_mask:0xf
    v_dot2c_f32_bf16 v42, s62, v113
    v_dot2c_f32_bf16 v43, s63, v113
    v_add_f32_dpp v226, v226, v226 quad_perm:[2,3,0,1] row_mask:0xf bank_mask:0xf
    v_dot2c_f32_bf16 v44, s62, v114
    v_dot2c_f32_bf16 v45, s63, v114
    v_add_f32_dpp v224, v224, v224 row_half_mirror row_mask:0xf bank_mask:0xf
    v_dot2c_f32_bf16 v46, s62, v115
    v_dot2c_f32_bf16 v47, s63, v115
    v_add_f32_dpp v226, v226, v226 row_half_mirror row_mask:0xf bank_mask:0xf
    v_mul_f32 v20, 0xbb000000, v224
    v_mul_f32 v21, 0x3b000000, v226
    v_pk_mul_f32 v[40:41], v[40:41], v[218:219] op_sel_hi:[1,0]
    v_pk_mul_f32 v[42:43], v[42:43], v[218:219] op_sel_hi:[1,0]
    v_pk_mul_f32 v[44:45], v[44:45], v[218:219] op_sel_hi:[1,0]
    v_pk_mul_f32 v[46:47], v[46:47], v[218:219] op_sel_hi:[1,0]
    buffer_load_dwordx4 v5, s[36:39], s57 offen offset:1024 lds
    v_cvt_pk_bf16_f32 v24, v40, v41
    v_cvt_pk_bf16_f32 v25, v42, v43
    v_cvt_pk_bf16_f32 v26, v44, v45
    v_cvt_pk_bf16_f32 v27, v46, v47
    ds_write_b128 v9, v[24:27] offset:1024
    v_dot2_f32_bf16 v48, v100, s60, v219
    v_dot2_f32_bf16 v49, v100, s61, v219
    v_fma_f32 v21, -v20, v20, v21
    v_dot2_f32_bf16 v50, v101, s60, v219
    v_dot2_f32_bf16 v51, v101, s61, v219
    v_cvt_pk_bf16_f32 v23, v20, v20
    v_dot2_f32_bf16 v52, v102, s60, v219
    v_dot2_f32_bf16 v53, v102, s61, v219
    v_max_f32 v21, 0, v21
    v_dot2_f32_bf16 v54, v103, s60, v219
    v_dot2_f32_bf16 v55, v103, s61, v219
    v_lshlrev_b32 v23, 16, v23
    buffer_load_dwordx4 v6, s[36:39], s57 offen offset:2048 lds
    v_dot2c_f32_bf16 v48, s62, v116
    v_dot2c_f32_bf16 v49, s63, v116
    v_cvt_pk_bf16_f32 v22, 0, v21
    v_dot2c_f32_bf16 v50, s62, v117
    v_dot2c_f32_bf16 v51, s63, v117
    v_sub_f32 v23, v20, v23
    v_dot2c_f32_bf16 v52, s62, v118
    v_dot2c_f32_bf16 v53, s63, v118
    v_add_f32 v22, 0x3727c5ac, v22
    v_dot2c_f32_bf16 v54, s62, v119
    v_dot2c_f32_bf16 v55, s63, v119
    v_cvt_pk_bf16_f32 v232, v20, v23
    v_cvt_pk_bf16_f32 v22, 0, v22
    v_mul_f32 v221, s101, v20
    v_pk_mul_f32 v[48:49], v[48:49], v[218:219] op_sel_hi:[1,0]
    v_pk_mul_f32 v[50:51], v[50:51], v[218:219] op_sel_hi:[1,0]
    v_pk_mul_f32 v[52:53], v[52:53], v[218:219] op_sel_hi:[1,0]
    v_pk_mul_f32 v[54:55], v[54:55], v[218:219] op_sel_hi:[1,0]
    buffer_load_dwordx4 v7, s[36:39], s57 offen offset:3072 lds
    v_cvt_pk_bf16_f32 v28, v48, v49
    v_cvt_pk_bf16_f32 v29, v50, v51
    v_cvt_pk_bf16_f32 v30, v52, v53
    v_cvt_pk_bf16_f32 v31, v54, v55
    ds_write_b128 v9, v[28:31] offset:17408
    v_dot2_f32_bf16 v40, v104, s60, v219
    v_dot2_f32_bf16 v41, v104, s61, v219
    v_sqrt_f32 v22, v22
    v_dot2_f32_bf16 v42, v105, s60, v219
    v_dot2_f32_bf16 v43, v105, s61, v219
    v_mov_b32 v235, s47
    v_dot2_f32_bf16 v44, v106, s60, v219
    v_dot2_f32_bf16 v45, v106, s61, v219
    v_cvt_pk_bf16_f32 v22, 0, v22
    v_dot2_f32_bf16 v46, v107, s60, v219
    v_dot2_f32_bf16 v47, v107, s61, v219
    v_rcp_f32 v220, v22
    s_add_u32 m0, s55, 12288
    s_nop 0
    buffer_load_dwordx4 v4, s[16:19], s57 offen offset:0 lds
    v_dot2c_f32_bf16 v40, s62, v120
    v_dot2c_f32_bf16 v41, s63, v120
    v_mul_f32 v23, 0xc4000000, v23
    v_dot2c_f32_bf16 v42, s62, v121
    v_dot2c_f32_bf16 v43, s63, v121
    v_mul_f32 v21, v21, v220
    v_dot2c_f32_bf16 v44, s62, v122
    v_dot2c_f32_bf16 v45, s63, v122
    v_mul_f32 v241, v23, v220
    v_dot2c_f32_bf16 v46, s62, v123
    v_dot2c_f32_bf16 v47, s63, v123
    v_mul_f32 v21, v21, v220
    v_cvt_pk_bf16_f32 v21, 0, v21
    v_add_f32 v21, 0x3727c5ac, v21
    v_pk_mul_f32 v[40:41], v[40:41], v[218:219] op_sel_hi:[1,0]
    v_pk_mul_f32 v[42:43], v[42:43], v[218:219] op_sel_hi:[1,0]
    v_pk_mul_f32 v[44:45], v[44:45], v[218:219] op_sel_hi:[1,0]
    v_pk_mul_f32 v[46:47], v[46:47], v[218:219] op_sel_hi:[1,0]
    buffer_load_dwordx4 v5, s[16:19], s57 offen offset:1024 lds
    v_cvt_pk_bf16_f32 v24, v40, v41
    v_cvt_pk_bf16_f32 v25, v42, v43
    v_cvt_pk_bf16_f32 v26, v44, v45
    v_cvt_pk_bf16_f32 v27, v46, v47
    ds_write_b128 v9, v[24:27] offset:33792
    v_dot2_f32_bf16 v48, v108, s60, v219
    v_dot2_f32_bf16 v49, v108, s61, v219
    v_cvt_pk_bf16_f32 v21, 0, v21
    v_dot2_f32_bf16 v50, v109, s60, v219
    v_dot2_f32_bf16 v51, v109, s61, v219
    v_sqrt_f32 v21, v21
    v_dot2_f32_bf16 v52, v110, s60, v219
    v_dot2_f32_bf16 v53, v110, s61, v219
    v_cvt_pk_bf16_f32 v21, 0, v21
    v_dot2_f32_bf16 v54, v111, s60, v219
    v_dot2_f32_bf16 v55, v111, s61, v219
    v_mul_f32 v234, v21, v22
    buffer_load_dwordx4 v6, s[16:19], s57 offen offset:2048 lds
    v_dot2c_f32_bf16 v48, s62, v124
    v_dot2c_f32_bf16 v49, s63, v124
    v_cvt_pk_bf16_f32 v21, 0, v234
    v_dot2c_f32_bf16 v50, s62, v125
    v_dot2c_f32_bf16 v51, s63, v125
    v_sub_f32 v21, v234, v21
    v_dot2c_f32_bf16 v52, s62, v126
    v_dot2c_f32_bf16 v53, s63, v126
    v_cvt_pk_bf16_f32 v233, v234, v21
    v_dot2c_f32_bf16 v54, s62, v127
    v_dot2c_f32_bf16 v55, s63, v127
    buffer_store_dwordx4 v[232:235], v3, s[40:43], 0 offen offset:256 sc1
    v_cmp_eq_u32 vcc, 2, v242
    s_nop 1
    v_cndmask_b32 v240, v240, v241, vcc
    v_pk_mul_f32 v[48:49], v[48:49], v[218:219] op_sel_hi:[1,0]
    v_pk_mul_f32 v[50:51], v[50:51], v[218:219] op_sel_hi:[1,0]
    v_pk_mul_f32 v[52:53], v[52:53], v[218:219] op_sel_hi:[1,0]
    v_pk_mul_f32 v[54:55], v[54:55], v[218:219] op_sel_hi:[1,0]
    buffer_load_dwordx4 v7, s[16:19], s57 offen offset:3072 lds
    v_cvt_pk_bf16_f32 v28, v48, v49
    v_cvt_pk_bf16_f32 v29, v50, v51
    v_cvt_pk_bf16_f32 v30, v52, v53
    v_cvt_pk_bf16_f32 v31, v54, v55
    ds_write_b128 v9, v[28:31] offset:50176
    s_waitcnt vmcnt(17)
    v_dot2_f32_bf16 v228, v160, s59, 0
    v_dot2_f32_bf16 v230, v160, v160, 0
    v_dot2_f32_bf16 v229, v161, s59, 0
    v_dot2_f32_bf16 v231, v161, v161, 0
    v_dot2c_f32_bf16 v228, s59, v162
    v_dot2c_f32_bf16 v230, v162, v162
    v_dot2c_f32_bf16 v229, s59, v163
    v_dot2c_f32_bf16 v231, v163, v163
    v_dot2c_f32_bf16 v228, s59, v164
    v_dot2c_f32_bf16 v230, v164, v164
    v_dot2c_f32_bf16 v229, s59, v165
    v_dot2c_f32_bf16 v231, v165, v165
    v_dot2c_f32_bf16 v228, s59, v166
    v_dot2c_f32_bf16 v230, v166, v166
    v_dot2c_f32_bf16 v229, s59, v167
    v_dot2c_f32_bf16 v231, v167, v167
    v_dot2c_f32_bf16 v228, s59, v168
    v_dot2c_f32_bf16 v230, v168, v168
    v_dot2c_f32_bf16 v229, s59, v169
    v_dot2c_f32_bf16 v231, v169, v169
    v_dot2c_f32_bf16 v228, s59, v170
    v_dot2c_f32_bf16 v230, v170, v170
    v_dot2c_f32_bf16 v229, s59, v171
    v_dot2c_f32_bf16 v231, v171, v171
    v_dot2c_f32_bf16 v228, s59, v172
    v_dot2c_f32_bf16 v230, v172, v172
    v_dot2c_f32_bf16 v229, s59, v173
    v_dot2c_f32_bf16 v231, v173, v173
    v_dot2c_f32_bf16 v228, s59, v174
    v_dot2c_f32_bf16 v230, v174, v174
    v_dot2c_f32_bf16 v229, s59, v175
    v_dot2c_f32_bf16 v231, v175, v175
    v_dot2c_f32_bf16 v228, s59, v176
    v_dot2c_f32_bf16 v230, v176, v176
    v_dot2c_f32_bf16 v229, s59, v177
    v_dot2c_f32_bf16 v231, v177, v177
    v_dot2c_f32_bf16 v228, s59, v178
    v_dot2c_f32_bf16 v230, v178, v178
    v_dot2c_f32_bf16 v229, s59, v179
    v_dot2c_f32_bf16 v231, v179, v179
    v_dot2c_f32_bf16 v228, s59, v180
    v_dot2c_f32_bf16 v230, v180, v180
    v_dot2c_f32_bf16 v229, s59, v181
    v_dot2c_f32_bf16 v231, v181, v181
    v_dot2c_f32_bf16 v228, s59, v182
    v_dot2c_f32_bf16 v230, v182, v182
    v_dot2c_f32_bf16 v229, s59, v183
    v_dot2c_f32_bf16 v231, v183, v183
    v_dot2c_f32_bf16 v228, s59, v184
    v_dot2c_f32_bf16 v230, v184, v184
    v_dot2c_f32_bf16 v229, s59, v185
    v_dot2c_f32_bf16 v231, v185, v185
    v_dot2c_f32_bf16 v228, s59, v186
    v_dot2c_f32_bf16 v230, v186, v186
    v_dot2c_f32_bf16 v229, s59, v187
    v_dot2c_f32_bf16 v231, v187, v187
    v_dot2c_f32_bf16 v228, s59, v188
    v_dot2c_f32_bf16 v230, v188, v188
    v_dot2c_f32_bf16 v229, s59, v189
    v_dot2c_f32_bf16 v231, v189, v189
    v_dot2c_f32_bf16 v228, s59, v190
    v_dot2c_f32_bf16 v230, v190, v190
    v_dot2c_f32_bf16 v229, s59, v191
    v_dot2c_f32_bf16 v231, v191, v191
    s_mul_i32 s31, s31, 9
    s_and_b32 s70, s30, 1
    s_lshl_b32 s70, s70, 2
    s_lshr_b32 s0, s31, 2
    s_add_u32 s0, s0, s31
    s_and_b32 s0, s0, 3
    s_add_u32 s70, s70, s0
    s_lshr_b32 s45, s30, 1
    s_lshl_b32 s45, s45, 2
    s_lshr_b32 s0, s31, 3
    s_add_u32 s45, s45, s0
    s_bfe_u32 s1, s31, 0x10002
    s_sub_u32 s0, 32, s45
    s_cmp_eq_u32 s45, 0
    s_cselect_b32 s0, 16, s0
    s_cmp_eq_u32 s1, 0
    s_cselect_b32 s71, s45, s0
    s_lshr_b32 s44, s31, 2
    s_mul_i32 s44, s44, 7
    s_lshr_b32 s44, s44, 2
    s_lshl_b32 s68, s44, 15
    s_lshl_b32 s69, s3, 13
    v_lshrrev_b32 v24, 3, v0
    v_bfe_u32 v25, v0, 4, 1
    v_lshlrev_b32 v26, 2, v25
    v_and_b32 v27, 7, v0
    v_xor_b32 v26, v26, v27
    v_lshlrev_b32 v26, 4, v26
    v_lshl_add_u32 v26, v24, 10, v26
    s_mul_i32 s0, s3, 458752
    s_lshl_b32 s1, s70, 7
    s_add_u32 s0, s0, s1
    v_add_u32 v246, s0, v26
    v_add_u32 v247, 7168, v246
    v_add_u32 v248, 14336, v246
    v_add_u32 v249, 21504, v246
    s_mov_b32 s64, s20
    s_mov_b32 s65, s21
    s_mov_b32 s66, 1835008
    s_mov_b32 s67, 0x20000
    v_dot2_f32_bf16 v40, v128, s60, v221
    v_dot2_f32_bf16 v41, v128, s61, v221
    v_add_f32 v228, v228, v229
    v_dot2_f32_bf16 v42, v129, s60, v221
    v_dot2_f32_bf16 v43, v129, s61, v221
    v_add_f32 v230, v230, v231
    v_dot2_f32_bf16 v44, v130, s60, v221
    v_dot2_f32_bf16 v45, v130, s61, v221
    v_add_f32_dpp v228, v228, v228 quad_perm:[1,0,3,2] row_mask:0xf bank_mask:0xf
    v_dot2_f32_bf16 v46, v131, s60, v221
    v_dot2_f32_bf16 v47, v131, s61, v221
    v_add_f32_dpp v230, v230, v230 quad_perm:[1,0,3,2] row_mask:0xf bank_mask:0xf
    s_add_u32 m0, s55, 16384
    s_nop 0
    buffer_load_dwordx4 v246, s[64:67], s68 offen offset:0 lds
    v_dot2c_f32_bf16 v40, s62, v144
    v_dot2c_f32_bf16 v41, s63, v144
    v_add_f32_dpp v228, v228, v228 quad_perm:[2,3,0,1] row_mask:0xf bank_mask:0xf
    v_dot2c_f32_bf16 v42, s62, v145
    v_dot2c_f32_bf16 v43, s63, v145
    v_add_f32_dpp v230, v230, v230 quad_perm:[2,3,0,1] row_mask:0xf bank_mask:0xf
    v_dot2c_f32_bf16 v44, s62, v146
    v_dot2c_f32_bf16 v45, s63, v146
    v_add_f32_dpp v228, v228, v228 row_half_mirror row_mask:0xf bank_mask:0xf
    v_dot2c_f32_bf16 v46, s62, v147
    v_dot2c_f32_bf16 v47, s63, v147
    v_add_f32_dpp v230, v230, v230 row_half_mirror row_mask:0xf bank_mask:0xf
    v_mul_f32 v20, 0xbb000000, v228
    v_mul_f32 v21, 0x3b000000, v230
    v_pk_mul_f32 v[40:41], v[40:41], v[220:221] op_sel_hi:[1,0]
    v_pk_mul_f32 v[42:43], v[42:43], v[220:221] op_sel_hi:[1,0]
    v_pk_mul_f32 v[44:45], v[44:45], v[220:221] op_sel_hi:[1,0]
    v_pk_mul_f32 v[46:47], v[46:47], v[220:221] op_sel_hi:[1,0]
    buffer_load_dwordx4 v247, s[64:67], s68 offen offset:1024 lds
    v_cvt_pk_bf16_f32 v24, v40, v41
    v_cvt_pk_bf16_f32 v25, v42, v43
    v_cvt_pk_bf16_f32 v26, v44, v45
    v_cvt_pk_bf16_f32 v27, v46, v47
    ds_write_b128 v8, v[24:27] offset:2048
    v_dot2_f32_bf16 v48, v132, s60, v221
    v_dot2_f32_bf16 v49, v132, s61, v221
    v_fma_f32 v21, -v20, v20, v21
    v_dot2_f32_bf16 v50, v133, s60, v221
    v_dot2_f32_bf16 v51, v133, s61, v221
    v_cvt_pk_bf16_f32 v23, v20, v20
    v_dot2_f32_bf16 v52, v134, s60, v221
    v_dot2_f32_bf16 v53, v134, s61, v221
    v_max_f32 v21, 0, v21
    v_dot2_f32_bf16 v54, v135, s60, v221
    v_dot2_f32_bf16 v55, v135, s61, v221
    v_lshlrev_b32 v23, 16, v23
    buffer_load_dwordx4 v248, s[64:67], s68 offen offset:2048 lds
    v_dot2c_f32_bf16 v48, s62, v148
    v_dot2c_f32_bf16 v49, s63, v148
    v_cvt_pk_bf16_f32 v22, 0, v21
    v_dot2c_f32_bf16 v50, s62, v149
    v_dot2c_f32_bf16 v51, s63, v149
    v_sub_f32 v23, v20, v23
    v_dot2c_f32_bf16 v52, s62, v150
    v_dot2c_f32_bf16 v53, s63, v150
    v_add_f32 v22, 0x3727c5ac, v22
    v_dot2c_f32_bf16 v54, s62, v151
    v_dot2c_f32_bf16 v55, s63, v151
    v_cvt_pk_bf16_f32 v236, v20, v23
    v_cvt_pk_bf16_f32 v22, 0, v22
    v_mul_f32 v223, s101, v20
    v_pk_mul_f32 v[48:49], v[48:49], v[220:221] op_sel_hi:[1,0]
    v_pk_mul_f32 v[50:51], v[50:51], v[220:221] op_sel_hi:[1,0]
    v_pk_mul_f32 v[52:53], v[52:53], v[220:221] op_sel_hi:[1,0]
    v_pk_mul_f32 v[54:55], v[54:55], v[220:221] op_sel_hi:[1,0]
    buffer_load_dwordx4 v249, s[64:67], s68 offen offset:3072 lds
    s_add_u32 s68, s68, 32768
    s_cmp_eq_u32 s68, 458752
    s_cselect_b32 s68, 0, s68
    v_cvt_pk_bf16_f32 v28, v48, v49
    v_cvt_pk_bf16_f32 v29, v50, v51
    v_cvt_pk_bf16_f32 v30, v52, v53
    v_cvt_pk_bf16_f32 v31, v54, v55
    ds_write_b128 v8, v[28:31] offset:18432
    v_dot2_f32_bf16 v40, v136, s60, v221
    v_dot2_f32_bf16 v41, v136, s61, v221
    v_sqrt_f32 v22, v22
    v_dot2_f32_bf16 v42, v137, s60, v221
    v_dot2_f32_bf16 v43, v137, s61, v221
    v_mov_b32 v239, s47
    v_dot2_f32_bf16 v44, v138, s60, v221
    v_dot2_f32_bf16 v45, v138, s61, v221
    v_cvt_pk_bf16_f32 v22, 0, v22
    v_dot2_f32_bf16 v46, v139, s60, v221
    v_dot2_f32_bf16 v47, v139, s61, v221
    v_rcp_f32 v222, v22
    s_add_u32 m0, s55, 20480
    s_nop 0
    buffer_load_dwordx4 v246, s[64:67], s68 offen offset:0 lds
    v_dot2c_f32_bf16 v40, s62, v152
    v_dot2c_f32_bf16 v41, s63, v152
    v_mul_f32 v23, 0xc4000000, v23
    v_dot2c_f32_bf16 v42, s62, v153
    v_dot2c_f32_bf16 v43, s63, v153
    v_mul_f32 v21, v21, v222
    v_dot2c_f32_bf16 v44, s62, v154
    v_dot2c_f32_bf16 v45, s63, v154
    v_mul_f32 v241, v23, v222
    v_dot2c_f32_bf16 v46, s62, v155
    v_dot2c_f32_bf16 v47, s63, v155
    v_mul_f32 v21, v21, v222
    v_cvt_pk_bf16_f32 v21, 0, v21
    v_add_f32 v21, 0x3727c5ac, v21
    v_pk_mul_f32 v[40:41], v[40:41], v[220:221] op_sel_hi:[1,0]
    v_pk_mul_f32 v[42:43], v[42:43], v[220:221] op_sel_hi:[1,0]
    v_pk_mul_f32 v[44:45], v[44:45], v[220:221] op_sel_hi:[1,0]
    v_pk_mul_f32 v[46:47], v[46:47], v[220:221] op_sel_hi:[1,0]
    buffer_load_dwordx4 v247, s[64:67], s68 offen offset:1024 lds
    v_cvt_pk_bf16_f32 v24, v40, v41
    v_cvt_pk_bf16_f32 v25, v42, v43
    v_cvt_pk_bf16_f32 v26, v44, v45
    v_cvt_pk_bf16_f32 v27, v46, v47
    ds_write_b128 v8, v[24:27] offset:34816
    v_dot2_f32_bf16 v48, v140, s60, v221
    v_dot2_f32_bf16 v49, v140, s61, v221
    v_cvt_pk_bf16_f32 v21, 0, v21
    v_dot2_f32_bf16 v50, v141, s60, v221
    v_dot2_f32_bf16 v51, v141, s61, v221
    v_sqrt_f32 v21, v21
    v_dot2_f32_bf16 v52, v142, s60, v221
    v_dot2_f32_bf16 v53, v142, s61, v221
    v_cvt_pk_bf16_f32 v21, 0, v21
    v_dot2_f32_bf16 v54, v143, s60, v221
    v_dot2_f32_bf16 v55, v143, s61, v221
    v_mul_f32 v238, v21, v22
    buffer_load_dwordx4 v248, s[64:67], s68 offen offset:2048 lds
    v_dot2c_f32_bf16 v48, s62, v156
    v_dot2c_f32_bf16 v49, s63, v156
    v_cvt_pk_bf16_f32 v21, 0, v238
    v_dot2c_f32_bf16 v50, s62, v157
    v_dot2c_f32_bf16 v51, s63, v157
    v_sub_f32 v21, v238, v21
    v_dot2c_f32_bf16 v52, s62, v158
    v_dot2c_f32_bf16 v53, s63, v158
    v_cvt_pk_bf16_f32 v237, v238, v21
    v_dot2c_f32_bf16 v54, s62, v159
    v_dot2c_f32_bf16 v55, s63, v159
    buffer_store_dwordx4 v[236:239], v3, s[40:43], 0 offen offset:384 sc1
    v_cmp_eq_u32 vcc, 3, v242
    s_nop 1
    v_cndmask_b32 v240, v240, v241, vcc
    buffer_store_dword v240, v244, s[40:43], 0 offen sc1
    v_pk_mul_f32 v[48:49], v[48:49], v[220:221] op_sel_hi:[1,0]
    v_pk_mul_f32 v[50:51], v[50:51], v[220:221] op_sel_hi:[1,0]
    v_pk_mul_f32 v[52:53], v[52:53], v[220:221] op_sel_hi:[1,0]
    v_pk_mul_f32 v[54:55], v[54:55], v[220:221] op_sel_hi:[1,0]
    buffer_load_dwordx4 v249, s[64:67], s68 offen offset:3072 lds
    s_add_u32 s68, s68, 32768
    s_cmp_eq_u32 s68, 458752
    s_cselect_b32 s68, 0, s68
    v_cvt_pk_bf16_f32 v28, v48, v49
    v_cvt_pk_bf16_f32 v29, v50, v51
    v_cvt_pk_bf16_f32 v30, v52, v53
    v_cvt_pk_bf16_f32 v31, v54, v55
    ds_write_b128 v8, v[28:31] offset:51200
    v_dot2_f32_bf16 v40, v160, s60, v223
    v_dot2_f32_bf16 v41, v160, s61, v223
    v_dot2_f32_bf16 v42, v161, s60, v223
    v_dot2_f32_bf16 v43, v161, s61, v223
    v_dot2_f32_bf16 v44, v162, s60, v223
    v_dot2_f32_bf16 v45, v162, s61, v223
    v_dot2_f32_bf16 v46, v163, s60, v223
    v_dot2_f32_bf16 v47, v163, s61, v223
    v_dot2c_f32_bf16 v40, s62, v176
    v_dot2c_f32_bf16 v41, s63, v176
    v_dot2c_f32_bf16 v42, s62, v177
    v_dot2c_f32_bf16 v43, s63, v177
    v_dot2c_f32_bf16 v44, s62, v178
    v_dot2c_f32_bf16 v45, s63, v178
    v_dot2c_f32_bf16 v46, s62, v179
    v_dot2c_f32_bf16 v47, s63, v179
    v_pk_mul_f32 v[40:41], v[40:41], v[222:223] op_sel_hi:[1,0]
    v_pk_mul_f32 v[42:43], v[42:43], v[222:223] op_sel_hi:[1,0]
    v_pk_mul_f32 v[44:45], v[44:45], v[222:223] op_sel_hi:[1,0]
    v_pk_mul_f32 v[46:47], v[46:47], v[222:223] op_sel_hi:[1,0]
    v_cvt_pk_bf16_f32 v24, v40, v41
    v_cvt_pk_bf16_f32 v25, v42, v43
    v_cvt_pk_bf16_f32 v26, v44, v45
    v_cvt_pk_bf16_f32 v27, v46, v47
    ds_write_b128 v9, v[24:27] offset:3072
    v_dot2_f32_bf16 v48, v164, s60, v223
    v_dot2_f32_bf16 v49, v164, s61, v223
    v_dot2_f32_bf16 v50, v165, s60, v223
    v_dot2_f32_bf16 v51, v165, s61, v223
    v_dot2_f32_bf16 v52, v166, s60, v223
    v_dot2_f32_bf16 v53, v166, s61, v223
    v_dot2_f32_bf16 v54, v167, s60, v223
    v_dot2_f32_bf16 v55, v167, s61, v223
    v_dot2c_f32_bf16 v48, s62, v180
    v_dot2c_f32_bf16 v49, s63, v180
    v_dot2c_f32_bf16 v50, s62, v181
    v_dot2c_f32_bf16 v51, s63, v181
    v_dot2c_f32_bf16 v52, s62, v182
    v_dot2c_f32_bf16 v53, s63, v182
    v_dot2c_f32_bf16 v54, s62, v183
    v_dot2c_f32_bf16 v55, s63, v183
    v_pk_mul_f32 v[48:49], v[48:49], v[222:223] op_sel_hi:[1,0]
    v_pk_mul_f32 v[50:51], v[50:51], v[222:223] op_sel_hi:[1,0]
    v_pk_mul_f32 v[52:53], v[52:53], v[222:223] op_sel_hi:[1,0]
    v_pk_mul_f32 v[54:55], v[54:55], v[222:223] op_sel_hi:[1,0]
    v_cvt_pk_bf16_f32 v28, v48, v49
    v_cvt_pk_bf16_f32 v29, v50, v51
    v_cvt_pk_bf16_f32 v30, v52, v53
    v_cvt_pk_bf16_f32 v31, v54, v55
    ds_write_b128 v9, v[28:31] offset:19456
    v_dot2_f32_bf16 v40, v168, s60, v223
    v_dot2_f32_bf16 v41, v168, s61, v223
    v_dot2_f32_bf16 v42, v169, s60, v223
    v_dot2_f32_bf16 v43, v169, s61, v223
    v_dot2_f32_bf16 v44, v170, s60, v223
    v_dot2_f32_bf16 v45, v170, s61, v223
    v_dot2_f32_bf16 v46, v171, s60, v223
    v_dot2_f32_bf16 v47, v171, s61, v223
    v_dot2c_f32_bf16 v40, s62, v184
    v_dot2c_f32_bf16 v41, s63, v184
    v_dot2c_f32_bf16 v42, s62, v185
    v_dot2c_f32_bf16 v43, s63, v185
    v_dot2c_f32_bf16 v44, s62, v186
    v_dot2c_f32_bf16 v45, s63, v186
    v_dot2c_f32_bf16 v46, s62, v187
    v_dot2c_f32_bf16 v47, s63, v187
    v_pk_mul_f32 v[40:41], v[40:41], v[222:223] op_sel_hi:[1,0]
    v_pk_mul_f32 v[42:43], v[42:43], v[222:223] op_sel_hi:[1,0]
    v_pk_mul_f32 v[44:45], v[44:45], v[222:223] op_sel_hi:[1,0]
    v_pk_mul_f32 v[46:47], v[46:47], v[222:223] op_sel_hi:[1,0]
    v_cvt_pk_bf16_f32 v24, v40, v41
    v_cvt_pk_bf16_f32 v25, v42, v43
    v_cvt_pk_bf16_f32 v26, v44, v45
    v_cvt_pk_bf16_f32 v27, v46, v47
    ds_write_b128 v9, v[24:27] offset:35840
    v_dot2_f32_bf16 v48, v172, s60, v223
    v_dot2_f32_bf16 v49, v172, s61, v223
    v_dot2_f32_bf16 v50, v173, s60, v223
    v_dot2_f32_bf16 v51, v173, s61, v223
    v_dot2_f32_bf16 v52, v174, s60, v223
    v_dot2_f32_bf16 v53, v174, s61, v223
    v_dot2_f32_bf16 v54, v175, s60, v223
    v_dot2_f32_bf16 v55, v175, s61, v223
    v_dot2c_f32_bf16 v48, s62, v188
    v_dot2c_f32_bf16 v49, s63, v188
    v_dot2c_f32_bf16 v50, s62, v189
    v_dot2c_f32_bf16 v51, s63, v189
    v_dot2c_f32_bf16 v52, s62, v190
    v_dot2c_f32_bf16 v53, s63, v190
    v_dot2c_f32_bf16 v54, s62, v191
    v_dot2c_f32_bf16 v55, s63, v191
    v_pk_mul_f32 v[48:49], v[48:49], v[222:223] op_sel_hi:[1,0]
    v_pk_mul_f32 v[50:51], v[50:51], v[222:223] op_sel_hi:[1,0]
    v_pk_mul_f32 v[52:53], v[52:53], v[222:223] op_sel_hi:[1,0]
    v_pk_mul_f32 v[54:55], v[54:55], v[222:223] op_sel_hi:[1,0]
    v_cvt_pk_bf16_f32 v28, v48, v49
    v_cvt_pk_bf16_f32 v29, v50, v51
    v_cvt_pk_bf16_f32 v30, v52, v53
    v_cvt_pk_bf16_f32 v31, v54, v55
    ds_write_b128 v9, v[28:31] offset:52224
    s_waitcnt lgkmcnt(0)
    s_barrier
    s_waitcnt vmcnt(19)
    ds_read_b128 v[32:35], v10 offset:0
    ds_read_b128 v[48:51], v14 offset:0
    ds_read_b128 v[52:55], v14 offset:4096
    ds_read_b128 v[36:39], v10 offset:4096
    ds_read_b128 v[40:43], v10 offset:8192
    ds_read_b128 v[44:47], v10 offset:12288
    v_lshrrev_b32 v24, 5, v0
    v_bfe_u32 v25, v0, 4, 1
    v_bfe_u32 v26, v0, 2, 2
    v_lshl_add_u32 v27, v24, 2, v26
    v_lshlrev_b32 v27, 7, v27
    v_lshrrev_b32 v26, 1, v26
    s_and_b32 s0, s3, 1
    v_xor_b32 v26, s0, v26
    v_lshl_add_u32 v27, v26, 6, v27
    v_lshl_add_u32 v27, v25, 5, v27
    v_and_b32 v26, 3, v0
    v_lshl_add_u32 v27, v26, 3, v27
    v_add_u32 v250, s69, v27
    v_xor_b32 v251, 64, v250
    v_add_u32 v252, 0x18000, v250
    v_add_u32 v253, 0x18000, v251
    s_sub_u32 s0, s55, s69
    v_add_u32 v18, s0, v250
    v_add_u32 v19, s0, v251
    s_waitcnt lgkmcnt(0)
    v_mfma_f32_32x32x16_bf16 v[64:79], v[32:35], v[48:51], 0
    ds_read_b128 v[216:219], v11 offset:0
    ds_read_b128 v[232:235], v15 offset:0
    ds_read_b128 v[236:239], v15 offset:4096
    v_mfma_f32_32x32x16_bf16 v[80:95], v[32:35], v[52:55], 0
    ds_read_b128 v[220:223], v11 offset:4096
    ds_read_b128 v[224:227], v11 offset:8192
    ds_read_b128 v[228:231], v11 offset:12288
    v_mfma_f32_32x32x16_bf16 v[96:111], v[36:39], v[48:51], 0
    s_waitcnt vmcnt(6)
    s_mov_b32 s72, s22
    s_mov_b32 s73, s23
    s_mov_b32 s74, 1024
    s_mov_b32 s75, 0x20000
    v_mfma_f32_32x32x16_bf16 v[112:127], v[36:39], v[52:55], 0
    s_mov_b32 s76, s4
    s_mov_b32 s77, s5
    s_mov_b32 s78, 2097152
    s_mov_b32 s79, 0x20000
    v_mfma_f32_32x32x16_bf16 v[128:143], v[40:43], v[48:51], 0
    s_and_b32 s0, s30, 1
    s_lshl_b32 s0, s0, 9
    s_add_u32 s0, s0, 65536
    v_and_b32 v27, 31, v0
    v_mfma_f32_32x32x16_bf16 v[144:159], v[40:43], v[52:55], 0
    ds_read_b64_tr_b16 a[0:1], v18 offset:16384
    ds_read_b64_tr_b16 a[2:3], v18 offset:17408
    ds_read_b64_tr_b16 a[4:5], v19 offset:16384
    ds_read_b64_tr_b16 a[6:7], v19 offset:17408
    v_mfma_f32_32x32x16_bf16 v[160:175], v[44:47], v[48:51], 0
    ds_read_b64_tr_b16 a[8:9], v18 offset:18432
    ds_read_b64_tr_b16 a[10:11], v18 offset:19456
    ds_read_b64_tr_b16 a[12:13], v19 offset:18432
    ds_read_b64_tr_b16 a[14:15], v19 offset:19456
    v_mfma_f32_32x32x16_bf16 v[176:191], v[44:47], v[52:55], 0
    v_lshl_add_u32 v62, v27, 2, s0
    s_mul_i32 s0, s3, 7
    s_lshr_b32 s0, s0, 1
    s_lshl_b32 s1, s45, 4
    s_waitcnt lgkmcnt(0)
    v_mfma_f32_32x32x16_bf16 v[64:79], v[216:219], v[232:235], v[64:79]
    ds_read_b128 v[32:35], v12 offset:0
    ds_read_b128 v[48:51], v16 offset:0
    ds_read_b128 v[52:55], v16 offset:4096
    v_mfma_f32_32x32x16_bf16 v[80:95], v[216:219], v[236:239], v[80:95]
    ds_read_b128 v[36:39], v12 offset:4096
    ds_read_b128 v[40:43], v12 offset:8192
    ds_read_b128 v[44:47], v12 offset:12288
    v_mfma_f32_32x32x16_bf16 v[96:111], v[220:223], v[232:235], v[96:111]
    s_waitcnt vmcnt(0)
    s_add_u32 m0, s55, 16384
    s_nop 0
    buffer_load_dwordx4 v246, s[64:67], s68 offen offset:0 lds
    s_add_u32 s0, s0, s1
    s_lshl_b32 s0, s0, 1
    v_mfma_f32_32x32x16_bf16 v[112:127], v[220:223], v[236:239], v[112:127]
    buffer_load_dwordx4 v247, s[64:67], s68 offen offset:1024 lds
    s_and_b32 s1, s30, 1
    s_add_u32 s0, s0, s1
    v_mfma_f32_32x32x16_bf16 v[128:143], v[224:227], v[232:235], v[128:143]
    buffer_load_dwordx4 v248, s[64:67], s68 offen offset:2048 lds
    s_lshl_b32 s0, s0, 7
    v_bfe_u32 v26, v0, 2, 2
    v_mfma_f32_32x32x16_bf16 v[144:159], v[224:227], v[236:239], v[144:159]
    ds_read_b64_tr_b16 a[16:17], v18 offset:20480
    ds_read_b64_tr_b16 a[18:19], v18 offset:21504
    ds_read_b64_tr_b16 a[20:21], v19 offset:20480
    ds_read_b64_tr_b16 a[22:23], v19 offset:21504
    v_mfma_f32_32x32x16_bf16 v[160:175], v[228:231], v[232:235], v[160:175]
    ds_read_b64_tr_b16 a[24:25], v18 offset:22528
    ds_read_b64_tr_b16 a[26:27], v18 offset:23552
    ds_read_b64_tr_b16 a[28:29], v19 offset:22528
    ds_read_b64_tr_b16 a[30:31], v19 offset:23552
    v_mfma_f32_32x32x16_bf16 v[176:191], v[228:231], v[236:239], v[176:191]
    buffer_load_dwordx4 v249, s[64:67], s68 offen offset:3072 lds
    s_add_u32 s68, s68, 32768
    s_cmp_eq_u32 s68, 458752
    s_cselect_b32 s68, 0, s68
    v_lshl_add_u32 v63, v26, 8, s0
    s_lshr_b32 s1, s3, 1
    s_waitcnt lgkmcnt(0)
    v_mfma_f32_32x32x16_bf16 v[64:79], v[32:35], v[48:51], v[64:79]
    ds_read_b128 v[216:219], v13 offset:0
    ds_read_b128 v[232:235], v17 offset:0
    ds_read_b128 v[236:239], v17 offset:4096
    v_mfma_f32_32x32x16_bf16 v[80:95], v[32:35], v[52:55], v[80:95]
    ds_read_b128 v[220:223], v13 offset:4096
    ds_read_b128 v[224:227], v13 offset:8192
    ds_read_b128 v[228:231], v13 offset:12288
    v_mfma_f32_32x32x16_bf16 v[96:111], v[36:39], v[48:51], v[96:111]
    s_add_u32 m0, s55, 20480
    s_nop 0
    buffer_load_dwordx4 v246, s[64:67], s68 offen offset:0 lds
    s_lshl_b32 s0, s1, 10
    v_lshl_add_u32 v59, v0, 4, s0
    v_mfma_f32_32x32x16_bf16 v[112:127], v[36:39], v[52:55], v[112:127]
    buffer_load_dwordx4 v247, s[64:67], s68 offen offset:1024 lds
    v_xor_b32 v60, 0x400, v59
    s_lshl_b32 s0, s1, 5
    v_mfma_f32_32x32x16_bf16 v[128:143], v[40:43], v[48:51], v[128:143]
    buffer_load_dwordx4 v248, s[64:67], s68 offen offset:2048 lds
    v_and_b32 v26, 31, v0
    v_add_u32 v25, s0, v26
    v_mfma_f32_32x32x16_bf16 v[144:159], v[40:43], v[52:55], v[144:159]
    buffer_load_dwordx4 v249, s[64:67], s68 offen offset:3072 lds
    s_add_u32 s68, s68, 32768
    s_cmp_eq_u32 s68, 458752
    s_cselect_b32 s68, 0, s68
    v_lshlrev_b32 v25, 5, v25
    v_add_u32 v245, s71, v25
    v_mfma_f32_32x32x16_bf16 v[160:175], v[44:47], v[48:51], v[160:175]
    s_lshl_b32 s0, s0, 15
    s_lshl_b32 s1, s71, 10
    s_add_u32 s1, s1, s0
    v_lshrrev_b32 v25, 2, v0
    v_mfma_f32_32x32x16_bf16 v[176:191], v[44:47], v[52:55], v[176:191]
    v_lshlrev_b32 v25, 15, v25
    v_lshrrev_b32 v27, 4, v0
    v_xor_b32 v27, v27, v0
    v_and_b32 v27, 3, v27
    s_waitcnt lgkmcnt(0)
    v_mfma_f32_32x32x16_bf16 v[64:79], v[216:219], v[232:235], v[64:79]
    ds_read_b128 v[32:35], v10 offset:16384
    ds_read_b128 v[48:51], v14 offset:8192
    ds_read_b128 v[52:55], v14 offset:12288
    v_mfma_f32_32x32x16_bf16 v[80:95], v[216:219], v[236:239], v[80:95]
    ds_read_b128 v[36:39], v10 offset:20480
    ds_read_b128 v[40:43], v10 offset:24576
    ds_read_b128 v[44:47], v10 offset:28672
    v_mfma_f32_32x32x16_bf16 v[96:111], v[220:223], v[232:235], v[96:111]
    s_xor_b32 s57, s100, 2
    s_lshl_b32 s57, s57, 7
    s_add_u32 m0, s55, 0
    s_nop 0
    buffer_load_dwordx4 v56, s[36:39], s57 offen offset:0 lds
    v_lshl_add_u32 v25, v27, 4, v25
    v_add_u32 v25, s1, v25
    v_mfma_f32_32x32x16_bf16 v[112:127], v[220:223], v[236:239], v[112:127]
    buffer_load_dwordx4 v5, s[36:39], s57 offen offset:1024 lds
    s_lshl_b32 s0, s70, 7
    s_and_b32 s1, s3, 1
    v_mfma_f32_32x32x16_bf16 v[128:143], v[224:227], v[232:235], v[128:143]
    buffer_load_dwordx4 v6, s[36:39], s57 offen offset:2048 lds
    s_lshl_b32 s1, s1, 6
    s_add_u32 s0, s0, s1
    v_mfma_f32_32x32x16_bf16 v[144:159], v[224:227], v[236:239], v[144:159]
    buffer_load_dwordx4 v7, s[36:39], s57 offen offset:3072 lds
    v_add_u32 v255, s0, v25
    v_lshl_add_u32 v254, v26, 1, s0
    v_mfma_f32_32x32x16_bf16 v[160:175], v[228:231], v[232:235], v[160:175]
    s_add_u32 m0, s55, 4096
    s_nop 0
    buffer_load_dwordx4 v4, s[16:19], s57 offen offset:0 lds
    s_lshr_b32 s0, s0, 1
    v_and_b32 v25, 20, v0
    v_mfma_f32_32x32x16_bf16 v[176:191], v[228:231], v[236:239], v[176:191]
    buffer_load_dwordx4 v5, s[16:19], s57 offen offset:1024 lds
    v_bfe_u32 v27, v0, 1, 1
    v_lshl_add_u32 v25, v27, 3, v25
    s_waitcnt lgkmcnt(0)
    v_mfma_f32_32x32x16_bf16 v[64:79], v[32:35], v[48:51], v[64:79]
    ds_read_b128 v[216:219], v11 offset:16384
    ds_read_b128 v[232:235], v15 offset:8192
    ds_read_b128 v[236:239], v15 offset:12288
    v_mfma_f32_32x32x16_bf16 v[80:95], v[32:35], v[52:55], v[80:95]
    ds_read_b128 v[220:223], v11 offset:20480
    ds_read_b128 v[224:227], v11 offset:24576
    ds_read_b128 v[228:231], v11 offset:28672
    v_mfma_f32_32x32x16_bf16 v[96:111], v[36:39], v[48:51], v[96:111]
    buffer_load_dwordx4 v6, s[16:19], s57 offen offset:2048 lds
    v_and_b32 v27, 1, v0
    v_lshl_add_u32 v25, v27, 1, v25
    v_mfma_f32_32x32x16_bf16 v[112:127], v[36:39], v[52:55], v[112:127]
    buffer_load_dwordx4 v7, s[16:19], s57 offen offset:3072 lds
    v_bfe_u32 v27, v0, 3, 1
    v_add3_u32 v26, v25, v27, s0
    v_mfma_f32_32x32x16_bf16 v[128:143], v[40:43], v[48:51], v[128:143]
    s_cmp_lt_u32 s70, 4
    s_cselect_b32 s0, 0, -1
    s_cselect_b32 s1, 0, 513
    v_xor_b32 v27, s0, v26
    v_mfma_f32_32x32x16_bf16 v[144:159], v[40:43], v[52:55], v[144:159]
    v_add_u32 v27, s1, v27
    v_and_b32 v28, 1, v27
    v_lshlrev_b32 v28, 11, v28
    v_bfe_u32 v27, v27, 1, 7
    v_mfma_f32_32x32x16_bf16 v[160:175], v[44:47], v[48:51], v[160:175]
    v_lshl_add_u32 v27, v27, 4, v28
    v_lshl_add_u32 v27, v24, 12, v27
    s_mul_i32 s0, s71, 65520
    s_sub_u32 s0, 0x200000, s0
    v_mfma_f32_32x32x16_bf16 v[176:191], v[44:47], v[52:55], v[176:191]
    v_add_u32 v28, s0, v27
    v_cmp_eq_u32 vcc, 0, v26
    s_nop 0
    s_nop 0
    v_cndmask_b32 v61, v27, v28, vcc
    s_waitcnt lgkmcnt(0)
    v_mfma_f32_32x32x16_bf16 v[64:79], v[216:219], v[232:235], v[64:79]
    ds_read_b128 v[32:35], v12 offset:16384
    ds_read_b128 v[48:51], v16 offset:8192
    ds_read_b128 v[52:55], v16 offset:12288
    v_mfma_f32_32x32x16_bf16 v[80:95], v[216:219], v[236:239], v[80:95]
    ds_read_b128 v[36:39], v12 offset:20480
    ds_read_b128 v[40:43], v12 offset:24576
    ds_read_b128 v[44:47], v12 offset:28672
    v_mfma_f32_32x32x16_bf16 v[96:111], v[220:223], v[232:235], v[96:111]
    s_waitcnt vmcnt(12)
    v_mov_b32 v28, 0x40000000
    s_cmp_eq_u32 s3, 0
    s_cselect_b32 s0, s46, 0x40000000
    v_cmp_gt_u32 vcc, 2, v0
    v_mfma_f32_32x32x16_bf16 v[112:127], v[220:223], v[236:239], v[112:127]
    v_lshl_add_u32 v30, v0, 9, s0
    s_nop 0
    v_cndmask_b32 v58, v28, v30, vcc
    v_mfma_f32_32x32x16_bf16 v[128:143], v[224:227], v[232:235], v[128:143]
    v_mfma_f32_32x32x16_bf16 v[144:159], v[224:227], v[236:239], v[144:159]
    ds_read_b64_tr_b16 a[32:33], v18 offset:16384
    ds_read_b64_tr_b16 a[34:35], v18 offset:17408
    ds_read_b64_tr_b16 a[36:37], v19 offset:16384
    ds_read_b64_tr_b16 a[38:39], v19 offset:17408
    v_mfma_f32_32x32x16_bf16 v[160:175], v[228:231], v[232:235], v[160:175]
    ds_read_b64_tr_b16 a[40:41], v18 offset:18432
    ds_read_b64_tr_b16 a[42:43], v18 offset:19456
    ds_read_b64_tr_b16 a[44:45], v19 offset:18432
    ds_read_b64_tr_b16 a[46:47], v19 offset:19456
    v_mfma_f32_32x32x16_bf16 v[176:191], v[228:231], v[236:239], v[176:191]
    s_waitcnt lgkmcnt(0)
    v_mfma_f32_32x32x16_bf16 v[64:79], v[32:35], v[48:51], v[64:79]
    ds_read_b128 v[216:219], v13 offset:16384
    ds_read_b128 v[232:235], v17 offset:8192
    ds_read_b128 v[236:239], v17 offset:12288
    v_mfma_f32_32x32x16_bf16 v[80:95], v[32:35], v[52:55], v[80:95]
    ds_read_b128 v[220:223], v13 offset:20480
    ds_read_b128 v[224:227], v13 offset:24576
    ds_read_b128 v[228:231], v13 offset:28672
    v_mfma_f32_32x32x16_bf16 v[96:111], v[36:39], v[48:51], v[96:111]
    s_waitcnt vmcnt(8)
    s_add_u32 m0, s55, 16384
    s_nop 0
    buffer_load_dwordx4 v246, s[64:67], s68 offen offset:0 lds
    v_mfma_f32_32x32x16_bf16 v[112:127], v[36:39], v[52:55], v[112:127]
    buffer_load_dwordx4 v247, s[64:67], s68 offen offset:1024 lds
    v_mfma_f32_32x32x16_bf16 v[128:143], v[40:43], v[48:51], v[128:143]
    buffer_load_dwordx4 v248, s[64:67], s68 offen offset:2048 lds
    v_mfma_f32_32x32x16_bf16 v[144:159], v[40:43], v[52:55], v[144:159]
    ds_read_b64_tr_b16 a[48:49], v18 offset:20480
    ds_read_b64_tr_b16 a[50:51], v18 offset:21504
    ds_read_b64_tr_b16 a[52:53], v19 offset:20480
    ds_read_b64_tr_b16 a[54:55], v19 offset:21504
    v_mfma_f32_32x32x16_bf16 v[160:175], v[44:47], v[48:51], v[160:175]
    ds_read_b64_tr_b16 a[56:57], v18 offset:22528
    ds_read_b64_tr_b16 a[58:59], v18 offset:23552
    ds_read_b64_tr_b16 a[60:61], v19 offset:22528
    ds_read_b64_tr_b16 a[62:63], v19 offset:23552
    v_mfma_f32_32x32x16_bf16 v[176:191], v[44:47], v[52:55], v[176:191]
    buffer_load_dwordx4 v249, s[64:67], s68 offen offset:3072 lds
    s_add_u32 s68, s68, 32768
    s_cmp_eq_u32 s68, 458752
    s_cselect_b32 s68, 0, s68
    s_waitcnt lgkmcnt(0)
    v_mfma_f32_32x32x16_bf16 v[64:79], v[216:219], v[232:235], v[64:79]
    s_waitcnt vmcnt(4)
    ds_read_b128 v[32:35], v10 offset:32768
    ds_read_b128 v[48:51], v14 offset:0
    ds_read_b128 v[52:55], v14 offset:4096
    v_mfma_f32_32x32x16_bf16 v[80:95], v[216:219], v[236:239], v[80:95]
    ds_read_b128 v[36:39], v10 offset:36864
    ds_read_b128 v[40:43], v10 offset:40960
    ds_read_b128 v[44:47], v10 offset:45056
    v_mfma_f32_32x32x16_bf16 v[96:111], v[220:223], v[232:235], v[96:111]
    s_xor_b32 s57, s100, 3
    s_lshl_b32 s57, s57, 7
    s_add_u32 m0, s55, 8192
    s_nop 0
    buffer_load_dwordx4 v56, s[36:39], s57 offen offset:0 lds
    v_mfma_f32_32x32x16_bf16 v[112:127], v[220:223], v[236:239], v[112:127]
    buffer_load_dwordx4 v5, s[36:39], s57 offen offset:1024 lds
    v_mfma_f32_32x32x16_bf16 v[128:143], v[224:227], v[232:235], v[128:143]
    buffer_load_dwordx4 v6, s[36:39], s57 offen offset:2048 lds
    v_mfma_f32_32x32x16_bf16 v[144:159], v[224:227], v[236:239], v[144:159]
    buffer_load_dwordx4 v7, s[36:39], s57 offen offset:3072 lds
    v_mfma_f32_32x32x16_bf16 v[160:175], v[228:231], v[232:235], v[160:175]
    s_add_u32 m0, s55, 12288
    s_nop 0
    buffer_load_dwordx4 v4, s[16:19], s57 offen offset:0 lds
    v_mfma_f32_32x32x16_bf16 v[176:191], v[228:231], v[236:239], v[176:191]
    buffer_load_dwordx4 v5, s[16:19], s57 offen offset:1024 lds
    s_waitcnt lgkmcnt(0)
    v_mfma_f32_32x32x16_bf16 v[64:79], v[32:35], v[48:51], v[64:79]
    s_barrier
    ds_read_b128 v[216:219], v11 offset:32768
    ds_read_b128 v[232:235], v15 offset:0
    ds_read_b128 v[236:239], v15 offset:4096
    v_mfma_f32_32x32x16_bf16 v[80:95], v[32:35], v[52:55], v[80:95]
    ds_read_b128 v[220:223], v11 offset:36864
    ds_read_b128 v[224:227], v11 offset:40960
    ds_read_b128 v[228:231], v11 offset:45056
    v_mfma_f32_32x32x16_bf16 v[96:111], v[36:39], v[48:51], v[96:111]
    buffer_load_dwordx4 v6, s[16:19], s57 offen offset:2048 lds
    v_and_b32 v2, 3, v0
    v_lshrrev_b32 v3, 5, v0
    v_mfma_f32_32x32x16_bf16 v[112:127], v[36:39], v[52:55], v[112:127]
    buffer_load_dwordx4 v7, s[16:19], s57 offen offset:3072 lds
    v_lshlrev_b32 v3, 4, v3
    v_lshl_add_u32 v2, v2, 7, v3
    v_mfma_f32_32x32x16_bf16 v[128:143], v[40:43], v[48:51], v[128:143]
    s_add_u32 m0, s55, 20480
    s_nop 0
    buffer_load_dwordx4 v246, s[64:67], s68 offen offset:0 lds
    v_add_u32 v2, s13, v2
    v_and_b32 v3, 28, v0
    v_mfma_f32_32x32x16_bf16 v[144:159], v[40:43], v[52:55], v[144:159]
    buffer_load_dwordx4 v247, s[64:67], s68 offen offset:1024 lds
    v_cmp_eq_u32 vcc, 0, v3
    v_mov_b32 v3, 0x40000000
    v_mfma_f32_32x32x16_bf16 v[160:175], v[44:47], v[48:51], v[160:175]
    buffer_load_dwordx4 v248, s[64:67], s68 offen offset:2048 lds
    s_nop 0
    v_cndmask_b32 v2, v3, v2, vcc
    v_mfma_f32_32x32x16_bf16 v[176:191], v[44:47], v[52:55], v[176:191]
    buffer_load_dwordx4 v249, s[64:67], s68 offen offset:3072 lds
    s_add_u32 s68, s68, 32768
    s_cmp_eq_u32 s68, 458752
    s_cselect_b32 s68, 0, s68
    s_waitcnt lgkmcnt(0)
    v_mfma_f32_32x32x16_bf16 v[64:79], v[216:219], v[232:235], v[64:79]
    ds_read_b128 v[32:35], v12 offset:32768
    ds_read_b128 v[48:51], v16 offset:0
    ds_read_b128 v[52:55], v16 offset:4096
    v_mfma_f32_32x32x16_bf16 v[80:95], v[216:219], v[236:239], v[80:95]
    ds_read_b128 v[36:39], v12 offset:36864
    ds_read_b128 v[40:43], v12 offset:40960
    ds_read_b128 v[44:47], v12 offset:45056
    v_mfma_f32_32x32x16_bf16 v[96:111], v[220:223], v[232:235], v[96:111]
    s_waitcnt vmcnt(12)
    buffer_load_dwordx4 v[20:23], v2, s[40:43], 0 offen offset:0 sc1
    v_mfma_f32_32x32x16_bf16 v[112:127], v[220:223], v[236:239], v[112:127]
    buffer_load_dwordx4 v[24:27], v2, s[40:43], 0 offen offset:32 sc1
    v_mfma_f32_32x32x16_bf16 v[128:143], v[224:227], v[232:235], v[128:143]
    buffer_load_dwordx4 v[28:31], v2, s[40:43], 0 offen offset:64 sc1
    v_mfma_f32_32x32x16_bf16 v[144:159], v[224:227], v[236:239], v[144:159]
    ds_read_b64_tr_b16 a[64:65], v18 offset:16384
    ds_read_b64_tr_b16 a[66:67], v18 offset:17408
    ds_read_b64_tr_b16 a[68:69], v19 offset:16384
    ds_read_b64_tr_b16 a[70:71], v19 offset:17408
    v_mfma_f32_32x32x16_bf16 v[160:175], v[228:231], v[232:235], v[160:175]
    ds_read_b64_tr_b16 a[72:73], v18 offset:18432
    ds_read_b64_tr_b16 a[74:75], v18 offset:19456
    ds_read_b64_tr_b16 a[76:77], v19 offset:18432
    ds_read_b64_tr_b16 a[78:79], v19 offset:19456
    v_mfma_f32_32x32x16_bf16 v[176:191], v[228:231], v[236:239], v[176:191]
    buffer_load_dwordx4 v[240:243], v2, s[40:43], 0 offen offset:96 sc1
    s_waitcnt lgkmcnt(0)
    v_mfma_f32_32x32x16_bf16 v[64:79], v[32:35], v[48:51], v[64:79]
    ds_read_b128 v[216:219], v13 offset:32768
    ds_read_b128 v[232:235], v17 offset:0
    ds_read_b128 v[236:239], v17 offset:4096
    v_mfma_f32_32x32x16_bf16 v[80:95], v[32:35], v[52:55], v[80:95]
    ds_read_b128 v[220:223], v13 offset:36864
    ds_read_b128 v[224:227], v13 offset:40960
    ds_read_b128 v[228:231], v13 offset:45056
    v_mfma_f32_32x32x16_bf16 v[96:111], v[36:39], v[48:51], v[96:111]
    s_waitcnt vmcnt(4)
    s_add_u32 m0, s55, 16384
    s_nop 0
    buffer_load_dwordx4 v246, s[64:67], s68 offen offset:0 lds
    v_mfma_f32_32x32x16_bf16 v[112:127], v[36:39], v[52:55], v[112:127]
    buffer_load_dwordx4 v247, s[64:67], s68 offen offset:1024 lds
    v_mfma_f32_32x32x16_bf16 v[128:143], v[40:43], v[48:51], v[128:143]
    buffer_load_dwordx4 v248, s[64:67], s68 offen offset:2048 lds
    v_mfma_f32_32x32x16_bf16 v[144:159], v[40:43], v[52:55], v[144:159]
    ds_read_b64_tr_b16 a[80:81], v18 offset:20480
    ds_read_b64_tr_b16 a[82:83], v18 offset:21504
    ds_read_b64_tr_b16 a[84:85], v19 offset:20480
    ds_read_b64_tr_b16 a[86:87], v19 offset:21504
    v_mfma_f32_32x32x16_bf16 v[160:175], v[44:47], v[48:51], v[160:175]
    ds_read_b64_tr_b16 a[88:89], v18 offset:22528
    ds_read_b64_tr_b16 a[90:91], v18 offset:23552
    ds_read_b64_tr_b16 a[92:93], v19 offset:22528
    ds_read_b64_tr_b16 a[94:95], v19 offset:23552
    v_mfma_f32_32x32x16_bf16 v[176:191], v[44:47], v[52:55], v[176:191]
    buffer_load_dwordx4 v249, s[64:67], s68 offen offset:3072 lds
    s_add_u32 s68, s68, 32768
    s_cmp_eq_u32 s68, 458752
    s_cselect_b32 s68, 0, s68
    s_waitcnt lgkmcnt(0)
    v_mfma_f32_32x32x16_bf16 v[64:79], v[216:219], v[232:235], v[64:79]
    ds_read_b128 v[32:35], v10 offset:49152
    ds_read_b128 v[48:51], v14 offset:8192
    ds_read_b128 v[52:55], v14 offset:12288
    v_mfma_f32_32x32x16_bf16 v[80:95], v[216:219], v[236:239], v[80:95]
    ds_read_b128 v[36:39], v10 offset:53248
    ds_read_b128 v[40:43], v10 offset:57344
    ds_read_b128 v[44:47], v10 offset:61440
    v_mfma_f32_32x32x16_bf16 v[96:111], v[220:223], v[232:235], v[96:111]
    s_add_u32 m0, s55, 20480
    s_nop 0
    buffer_load_dwordx4 v246, s[64:67], s68 offen offset:0 lds
    v_mfma_f32_32x32x16_bf16 v[112:127], v[220:223], v[236:239], v[112:127]
    buffer_load_dwordx4 v247, s[64:67], s68 offen offset:1024 lds
    v_mfma_f32_32x32x16_bf16 v[128:143], v[224:227], v[232:235], v[128:143]
    buffer_load_dwordx4 v248, s[64:67], s68 offen offset:2048 lds
    v_mfma_f32_32x32x16_bf16 v[144:159], v[224:227], v[236:239], v[144:159]
    buffer_load_dwordx4 v249, s[64:67], s68 offen offset:3072 lds
    s_add_u32 s68, s68, 32768
    s_cmp_eq_u32 s68, 458752
    s_cselect_b32 s68, 0, s68
    v_mfma_f32_32x32x16_bf16 v[160:175], v[228:231], v[232:235], v[160:175]
    s_add_u32 m0, s55, 0
    s_nop 0
    buffer_load_dwordx4 v246, s[64:67], s68 offen offset:0 lds
    v_mfma_f32_32x32x16_bf16 v[176:191], v[228:231], v[236:239], v[176:191]
    buffer_load_dwordx4 v247, s[64:67], s68 offen offset:1024 lds
    s_waitcnt lgkmcnt(0)
    v_mfma_f32_32x32x16_bf16 v[64:79], v[32:35], v[48:51], v[64:79]
    ds_read_b128 v[216:219], v11 offset:49152
    ds_read_b128 v[232:235], v15 offset:8192
    ds_read_b128 v[236:239], v15 offset:12288
    v_mfma_f32_32x32x16_bf16 v[80:95], v[32:35], v[52:55], v[80:95]
    ds_read_b128 v[220:223], v11 offset:53248
    ds_read_b128 v[224:227], v11 offset:57344
    ds_read_b128 v[228:231], v11 offset:61440
    v_mfma_f32_32x32x16_bf16 v[96:111], v[36:39], v[48:51], v[96:111]
    buffer_load_dwordx4 v248, s[64:67], s68 offen offset:2048 lds
    v_mfma_f32_32x32x16_bf16 v[112:127], v[36:39], v[52:55], v[112:127]
    buffer_load_dwordx4 v249, s[64:67], s68 offen offset:3072 lds
    s_add_u32 s68, s68, 32768
    s_cmp_eq_u32 s68, 458752
    s_cselect_b32 s68, 0, s68
    v_mfma_f32_32x32x16_bf16 v[128:143], v[40:43], v[48:51], v[128:143]
    s_add_u32 m0, s55, 4096
    s_nop 0
    buffer_load_dwordx4 v246, s[64:67], s68 offen offset:0 lds
    v_mfma_f32_32x32x16_bf16 v[144:159], v[40:43], v[52:55], v[144:159]
    buffer_load_dwordx4 v247, s[64:67], s68 offen offset:1024 lds
    v_mfma_f32_32x32x16_bf16 v[160:175], v[44:47], v[48:51], v[160:175]
    buffer_load_dwordx4 v248, s[64:67], s68 offen offset:2048 lds
    v_mfma_f32_32x32x16_bf16 v[176:191], v[44:47], v[52:55], v[176:191]
    buffer_load_dwordx4 v249, s[64:67], s68 offen offset:3072 lds
    s_add_u32 s68, s68, 32768
    s_cmp_eq_u32 s68, 458752
    s_cselect_b32 s68, 0, s68
    s_waitcnt lgkmcnt(0)
    v_mfma_f32_32x32x16_bf16 v[64:79], v[216:219], v[232:235], v[64:79]
    ds_read_b128 v[32:35], v12 offset:49152
    ds_read_b128 v[48:51], v16 offset:8192
    ds_read_b128 v[52:55], v16 offset:12288
    v_mfma_f32_32x32x16_bf16 v[80:95], v[216:219], v[236:239], v[80:95]
    ds_read_b128 v[36:39], v12 offset:53248
    ds_read_b128 v[40:43], v12 offset:57344
    ds_read_b128 v[44:47], v12 offset:61440
    v_mfma_f32_32x32x16_bf16 v[96:111], v[220:223], v[232:235], v[96:111]
    s_waitcnt vmcnt(12)
    v_mfma_f32_32x32x16_bf16 v[112:127], v[220:223], v[236:239], v[112:127]
    v_mfma_f32_32x32x16_bf16 v[128:143], v[224:227], v[232:235], v[128:143]
    v_mfma_f32_32x32x16_bf16 v[144:159], v[224:227], v[236:239], v[144:159]
    ds_read_b64_tr_b16 a[96:97], v18 offset:16384
    ds_read_b64_tr_b16 a[98:99], v18 offset:17408
    ds_read_b64_tr_b16 a[100:101], v19 offset:16384
    ds_read_b64_tr_b16 a[102:103], v19 offset:17408
    v_mfma_f32_32x32x16_bf16 v[160:175], v[228:231], v[232:235], v[160:175]
    ds_read_b64_tr_b16 a[104:105], v18 offset:18432
    ds_read_b64_tr_b16 a[106:107], v18 offset:19456
    ds_read_b64_tr_b16 a[108:109], v19 offset:18432
    ds_read_b64_tr_b16 a[110:111], v19 offset:19456
    v_mfma_f32_32x32x16_bf16 v[176:191], v[228:231], v[236:239], v[176:191]
    s_waitcnt lgkmcnt(0)
    v_mfma_f32_32x32x16_bf16 v[64:79], v[32:35], v[48:51], v[64:79]
    ds_read_b128 v[216:219], v13 offset:49152
    ds_read_b128 v[232:235], v17 offset:8192
    ds_read_b128 v[236:239], v17 offset:12288
    v_mfma_f32_32x32x16_bf16 v[80:95], v[32:35], v[52:55], v[80:95]
    ds_read_b128 v[220:223], v13 offset:53248
    ds_read_b128 v[224:227], v13 offset:57344
    ds_read_b128 v[228:231], v13 offset:61440
    v_mfma_f32_32x32x16_bf16 v[96:111], v[36:39], v[48:51], v[96:111]
    s_waitcnt vmcnt(8)
    s_add_u32 m0, s55, 16384
    s_nop 0
    buffer_load_dwordx4 v246, s[64:67], s68 offen offset:0 lds
    v_mfma_f32_32x32x16_bf16 v[112:127], v[36:39], v[52:55], v[112:127]
    buffer_load_dwordx4 v247, s[64:67], s68 offen offset:1024 lds
    v_mfma_f32_32x32x16_bf16 v[128:143], v[40:43], v[48:51], v[128:143]
    buffer_load_dwordx4 v248, s[64:67], s68 offen offset:2048 lds
    v_mfma_f32_32x32x16_bf16 v[144:159], v[40:43], v[52:55], v[144:159]
    ds_read_b64_tr_b16 a[112:113], v18 offset:20480
    ds_read_b64_tr_b16 a[114:115], v18 offset:21504
    ds_read_b64_tr_b16 a[116:117], v19 offset:20480
    ds_read_b64_tr_b16 a[118:119], v19 offset:21504
    v_mfma_f32_32x32x16_bf16 v[160:175], v[44:47], v[48:51], v[160:175]
    ds_read_b64_tr_b16 a[120:121], v18 offset:22528
    ds_read_b64_tr_b16 a[122:123], v18 offset:23552
    ds_read_b64_tr_b16 a[124:125], v19 offset:22528
    ds_read_b64_tr_b16 a[126:127], v19 offset:23552
    v_mfma_f32_32x32x16_bf16 v[176:191], v[44:47], v[52:55], v[176:191]
    buffer_load_dwordx4 v249, s[64:67], s68 offen offset:3072 lds
    s_add_u32 s68, s68, 32768
    s_cmp_eq_u32 s68, 458752
    s_cselect_b32 s68, 0, s68
    s_waitcnt lgkmcnt(0)
    v_mfma_f32_32x32x16_bf16 v[64:79], v[216:219], v[232:235], v[64:79]
    v_mfma_f32_32x32x16_bf16 v[80:95], v[216:219], v[236:239], v[80:95]
    v_mfma_f32_32x32x16_bf16 v[96:111], v[220:223], v[232:235], v[96:111]
    s_add_u32 m0, s55, 20480
    s_nop 0
    buffer_load_dwordx4 v246, s[64:67], s68 offen offset:0 lds
    v_cvt_pk_bf16_f32 v20, v20, v21
    v_cvt_pk_bf16_f32 v21, v22, v23
    v_mfma_f32_32x32x16_bf16 v[112:127], v[220:223], v[236:239], v[112:127]
    buffer_load_dwordx4 v247, s[64:67], s68 offen offset:1024 lds
    v_cvt_pk_bf16_f32 v22, v24, v25
    v_cvt_pk_bf16_f32 v23, v26, v27
    v_mfma_f32_32x32x16_bf16 v[128:143], v[224:227], v[232:235], v[128:143]
    buffer_load_dwordx4 v248, s[64:67], s68 offen offset:2048 lds
    v_cvt_pk_bf16_f32 v28, v28, v29
    v_cvt_pk_bf16_f32 v29, v30, v31
    v_mfma_f32_32x32x16_bf16 v[144:159], v[224:227], v[236:239], v[144:159]
    buffer_load_dwordx4 v249, s[64:67], s68 offen offset:3072 lds
    s_add_u32 s68, s68, 32768
    s_cmp_eq_u32 s68, 458752
    s_cselect_b32 s68, 0, s68
    v_cvt_pk_bf16_f32 v30, v240, v241
    v_cvt_pk_bf16_f32 v31, v242, v243
    v_mfma_f32_32x32x16_bf16 v[160:175], v[228:231], v[232:235], v[160:175]
    v_mfma_f32_32x32x16_bf16 v[176:191], v[228:231], v[236:239], v[176:191]
    v_cvt_pk_bf16_f32 v32, v64, v65
    v_cvt_pk_bf16_f32 v33, v66, v67
    v_cvt_pk_bf16_f32 v34, v68, v69
    v_cvt_pk_bf16_f32 v35, v70, v71
    v_cvt_pk_bf16_f32 v36, v72, v73
    v_cvt_pk_bf16_f32 v37, v74, v75
    v_cvt_pk_bf16_f32 v38, v76, v77
    v_cvt_pk_bf16_f32 v39, v78, v79
    v_cvt_pk_bf16_f32 v40, v80, v81
    v_cvt_pk_bf16_f32 v41, v82, v83
    v_cvt_pk_bf16_f32 v42, v84, v85
    v_cvt_pk_bf16_f32 v43, v86, v87
    v_cvt_pk_bf16_f32 v44, v88, v89
    v_cvt_pk_bf16_f32 v45, v90, v91
    v_cvt_pk_bf16_f32 v46, v92, v93
    v_cvt_pk_bf16_f32 v47, v94, v95
    v_mfma_f32_32x32x16_bf16 v[64:79], v[192:195], v[32:35], 0
    v_cvt_pk_bf16_f32 v216, v96, v97
    v_cvt_pk_bf16_f32 v217, v98, v99
    s_add_u32 m0, s55, 8192
    s_nop 0
    buffer_load_dwordx4 v246, s[64:67], s68 offen offset:0 lds
    v_mfma_f32_32x32x16_bf16 v[80:95], v[192:195], v[40:43], 0
    v_cvt_pk_bf16_f32 v218, v100, v101
    v_cvt_pk_bf16_f32 v219, v102, v103
    buffer_load_dwordx4 v247, s[64:67], s68 offen offset:1024 lds
    v_mfma_f32_32x32x16_bf16 v[64:79], v[196:199], v[36:39], v[64:79]
    v_cvt_pk_bf16_f32 v220, v104, v105
    v_cvt_pk_bf16_f32 v221, v106, v107
    buffer_load_dwordx4 v248, s[64:67], s68 offen offset:2048 lds
    v_mfma_f32_32x32x16_bf16 v[80:95], v[196:199], v[44:47], v[80:95]
    v_cvt_pk_bf16_f32 v222, v108, v109
    v_cvt_pk_bf16_f32 v223, v110, v111
    buffer_load_dwordx4 v249, s[64:67], s68 offen offset:3072 lds
    s_add_u32 s68, s68, 32768
    s_cmp_eq_u32 s68, 458752
    s_cselect_b32 s68, 0, s68
    v_mfma_f32_32x32x16_bf16 v[64:79], v[200:203], v[40:43], v[64:79]
    v_cvt_pk_bf16_f32 v224, v112, v113
    v_cvt_pk_bf16_f32 v225, v114, v115
    s_add_u32 m0, s55, 12288
    s_nop 0
    buffer_load_dwordx4 v246, s[64:67], s68 offen offset:0 lds
    v_mfma_f32_32x32x16_bf16 v[80:95], v[208:211], v[32:35], v[80:95]
    v_cvt_pk_bf16_f32 v226, v116, v117
    v_cvt_pk_bf16_f32 v227, v118, v119
    buffer_load_dwordx4 v247, s[64:67], s68 offen offset:1024 lds
    v_mfma_f32_32x32x16_bf16 v[64:79], v[204:207], v[44:47], v[64:79]
    v_cvt_pk_bf16_f32 v228, v120, v121
    v_cvt_pk_bf16_f32 v229, v122, v123
    buffer_load_dwordx4 v248, s[64:67], s68 offen offset:2048 lds
    v_mfma_f32_32x32x16_bf16 v[80:95], v[212:215], v[36:39], v[80:95]
    v_cvt_pk_bf16_f32 v230, v124, v125
    v_cvt_pk_bf16_f32 v231, v126, v127
    buffer_load_dwordx4 v249, s[64:67], s68 offen offset:3072 lds
    v_mfma_f32_32x32x16_bf16 v[96:111], v[192:195], v[216:219], 0
    v_cvt_pk_bf16_f32 v32, v128, v129
    v_cvt_pk_bf16_f32 v33, v130, v131
    s_waitcnt vmcnt(20)
    ds_read_b64_tr_b16 a[128:129], v18 offset:0
    ds_read_b64_tr_b16 a[130:131], v18 offset:1024
    ds_read_b64_tr_b16 a[132:133], v19 offset:0
    ds_read_b64_tr_b16 a[134:135], v19 offset:1024
    v_mfma_f32_32x32x16_bf16 v[112:127], v[192:195], v[224:227], 0
    v_cvt_pk_bf16_f32 v34, v132, v133
    v_cvt_pk_bf16_f32 v35, v134, v135
    ds_read_b64_tr_b16 a[136:137], v18 offset:2048
    ds_read_b64_tr_b16 a[138:139], v18 offset:3072
    ds_read_b64_tr_b16 a[140:141], v19 offset:2048
    ds_read_b64_tr_b16 a[142:143], v19 offset:3072
    v_mfma_f32_32x32x16_bf16 v[96:111], v[196:199], v[220:223], v[96:111]
    v_cvt_pk_bf16_f32 v36, v136, v137
    v_cvt_pk_bf16_f32 v37, v138, v139
    s_waitcnt vmcnt(16)
    ds_read_b64_tr_b16 a[144:145], v18 offset:4096
    ds_read_b64_tr_b16 a[146:147], v18 offset:5120
    ds_read_b64_tr_b16 a[148:149], v19 offset:4096
    ds_read_b64_tr_b16 a[150:151], v19 offset:5120
    v_mfma_f32_32x32x16_bf16 v[112:127], v[196:199], v[228:231], v[112:127]
    v_cvt_pk_bf16_f32 v38, v140, v141
    v_cvt_pk_bf16_f32 v39, v142, v143
    ds_read_b64_tr_b16 a[152:153], v18 offset:6144
    ds_read_b64_tr_b16 a[154:155], v18 offset:7168
    ds_read_b64_tr_b16 a[156:157], v19 offset:6144
    ds_read_b64_tr_b16 a[158:159], v19 offset:7168
    v_mfma_f32_32x32x16_bf16 v[96:111], v[200:203], v[224:227], v[96:111]
    v_cvt_pk_bf16_f32 v40, v144, v145
    v_cvt_pk_bf16_f32 v41, v146, v147
    v_mfma_f32_32x32x16_bf16 v[112:127], v[208:211], v[216:219], v[112:127]
    v_cvt_pk_bf16_f32 v42, v148, v149
    v_cvt_pk_bf16_f32 v43, v150, v151
    v_mfma_f32_32x32x16_bf16 v[96:111], v[204:207], v[228:231], v[96:111]
    v_cvt_pk_bf16_f32 v44, v152, v153
    v_cvt_pk_bf16_f32 v45, v154, v155
    v_mfma_f32_32x32x16_bf16 v[112:127], v[212:215], v[220:223], v[112:127]
    v_cvt_pk_bf16_f32 v46, v156, v157
    v_cvt_pk_bf16_f32 v47, v158, v159
    v_mfma_f32_32x32x16_bf16 v[128:143], v[192:195], v[32:35], 0
    v_cvt_pk_bf16_f32 v216, v160, v161
    v_cvt_pk_bf16_f32 v217, v162, v163
    v_mfma_f32_32x32x16_bf16 v[144:159], v[192:195], v[40:43], 0
    v_cvt_pk_bf16_f32 v218, v164, v165
    v_cvt_pk_bf16_f32 v219, v166, v167
    v_mfma_f32_32x32x16_bf16 v[128:143], v[196:199], v[36:39], v[128:143]
    v_cvt_pk_bf16_f32 v220, v168, v169
    v_cvt_pk_bf16_f32 v221, v170, v171
    v_mfma_f32_32x32x16_bf16 v[144:159], v[196:199], v[44:47], v[144:159]
    v_cvt_pk_bf16_f32 v222, v172, v173
    v_cvt_pk_bf16_f32 v223, v174, v175
    v_mfma_f32_32x32x16_bf16 v[128:143], v[200:203], v[40:43], v[128:143]
    v_cvt_pk_bf16_f32 v224, v176, v177
    v_cvt_pk_bf16_f32 v225, v178, v179
    v_mfma_f32_32x32x16_bf16 v[144:159], v[208:211], v[32:35], v[144:159]
    v_cvt_pk_bf16_f32 v226, v180, v181
    v_cvt_pk_bf16_f32 v227, v182, v183
    v_mfma_f32_32x32x16_bf16 v[128:143], v[204:207], v[44:47], v[128:143]
    v_cvt_pk_bf16_f32 v228, v184, v185
    v_cvt_pk_bf16_f32 v229, v186, v187
    v_mfma_f32_32x32x16_bf16 v[144:159], v[212:215], v[36:39], v[144:159]
    v_cvt_pk_bf16_f32 v230, v188, v189
    v_cvt_pk_bf16_f32 v231, v190, v191
    v_mfma_f32_32x32x16_bf16 v[160:175], v[192:195], v[216:219], 0
    v_mfma_f32_32x32x16_bf16 v[176:191], v[192:195], v[224:227], 0
    v_mfma_f32_32x32x16_bf16 v[160:175], v[196:199], v[220:223], v[160:175]
    v_mfma_f32_32x32x16_bf16 v[176:191], v[196:199], v[228:231], v[176:191]
    v_mfma_f32_32x32x16_bf16 v[160:175], v[200:203], v[224:227], v[160:175]
    v_mfma_f32_32x32x16_bf16 v[176:191], v[208:211], v[216:219], v[176:191]
    v_mfma_f32_32x32x16_bf16 v[160:175], v[204:207], v[228:231], v[160:175]
    v_mfma_f32_32x32x16_bf16 v[176:191], v[212:215], v[220:223], v[176:191]
    buffer_load_ushort v254, v254, s[72:75], 0 offen
    v_add_u32 v241, 8192, v18
    v_add_u32 v242, 8192, v19
    v_add_u32 v243, 16384, v18
    v_add_u32 v244, 16384, v19
    s_add_u32 s36, s28, 8388608
    s_addc_u32 s37, s29, 0
    s_mov_b32 s38, 4194304
    s_mov_b32 s39, 0x20000
    v_and_b32 v24, 31, v0
    v_lshrrev_b32 v25, 5, v0
    v_lshlrev_b32 v24, 4, v24
    v_lshl_add_u32 v24, v25, 18, v24
    s_lshl_b32 s53, s3, 9
    v_add_u32 v24, s53, v24
    s_lshl_b32 s53, s48, 1
    s_add_u32 s53, s53, s49
    s_lshl_b32 s53, s53, 11
    v_cvt_pk_bf16_f32 v32, v64, v80
    v_cvt_pk_bf16_f32 v33, v96, v112
    v_cvt_pk_bf16_f32 v34, v128, v144
    v_cvt_pk_bf16_f32 v35, v160, v176
    s_add_u32 s54, s53, 0
    buffer_store_dwordx4 v[32:35], v24, s[36:39], s54 offen sc1
    v_mfma_f32_32x32x16_bf16 a[224:239], v[20:23], v[192:195], 0
    v_cvt_pk_bf16_f32 v36, v65, v81
    v_cvt_pk_bf16_f32 v37, v97, v113
    v_cvt_pk_bf16_f32 v38, v129, v145
    v_cvt_pk_bf16_f32 v39, v161, v177
    s_add_u32 s54, s53, 65536
    buffer_store_dwordx4 v[36:39], v24, s[36:39], s54 offen sc1
    v_mfma_f32_32x32x16_bf16 a[240:255], v[20:23], v[208:211], 0
    v_cvt_pk_bf16_f32 v40, v66, v82
    v_cvt_pk_bf16_f32 v41, v98, v114
    v_cvt_pk_bf16_f32 v42, v130, v146
    v_cvt_pk_bf16_f32 v43, v162, v178
    s_add_u32 s54, s53, 131072
    buffer_store_dwordx4 v[40:43], v24, s[36:39], s54 offen sc1
    v_mfma_f32_32x32x16_bf16 a[224:239], v[28:31], v[196:199], a[224:239]
    v_cvt_pk_bf16_f32 v44, v67, v83
    v_cvt_pk_bf16_f32 v45, v99, v115
    v_cvt_pk_bf16_f32 v46, v131, v147
    v_cvt_pk_bf16_f32 v47, v163, v179
    s_add_u32 s54, s53, 196608
    buffer_store_dwordx4 v[44:47], v24, s[36:39], s54 offen sc1
    v_mfma_f32_32x32x16_bf16 a[240:255], v[28:31], v[212:215], a[240:255]
    v_cvt_pk_bf16_f32 v32, v68, v84
    v_cvt_pk_bf16_f32 v33, v100, v116
    v_cvt_pk_bf16_f32 v34, v132, v148
    v_cvt_pk_bf16_f32 v35, v164, v180
    s_add_u32 s54, s53, 524288
    buffer_store_dwordx4 v[32:35], v24, s[36:39], s54 offen sc1
    v_cvt_pk_bf16_f32 v36, v69, v85
    v_cvt_pk_bf16_f32 v37, v101, v117
    v_cvt_pk_bf16_f32 v38, v133, v149
    v_cvt_pk_bf16_f32 v39, v165, v181
    s_add_u32 s54, s53, 589824
    buffer_store_dwordx4 v[36:39], v24, s[36:39], s54 offen sc1
    v_cvt_pk_bf16_f32 v40, v70, v86
    v_cvt_pk_bf16_f32 v41, v102, v118
    v_cvt_pk_bf16_f32 v42, v134, v150
    v_cvt_pk_bf16_f32 v43, v166, v182
    s_add_u32 s54, s53, 655360
    buffer_store_dwordx4 v[40:43], v24, s[36:39], s54 offen sc1
    v_accvgpr_read_b32 v48, a224
    v_accvgpr_read_b32 v49, a240
    v_accvgpr_read_b32 v50, a225
    v_accvgpr_read_b32 v51, a241
    v_accvgpr_read_b32 v52, a226
    v_accvgpr_read_b32 v53, a242
    v_accvgpr_read_b32 v54, a227
    v_accvgpr_read_b32 v55, a243
    s_lshl_b32 s0, s48, 12
    s_add_u32 s0, s0, 0x200000
    s_lshl_b32 s1, s49, 2
    s_add_u32 s1, s1, s3
    s_cmp_eq_u32 s1, 1
    s_cselect_b32 s0, s0, 0x40000000
    v_lshl_add_u32 v2, v0, 4, s0
    v_mov_b32 v3, 0x40000000
    v_cmp_gt_u32 vcc, 32, v0
    v_cvt_pk_bf16_f32 v28, v48, v49
    v_cvt_pk_bf16_f32 v29, v50, v51
    v_cvt_pk_bf16_f32 v30, v52, v53
    v_cvt_pk_bf16_f32 v31, v54, v55
    v_cndmask_b32 v2, v3, v2, vcc
    buffer_store_dwordx4 v[28:31], v2, s[36:39], 0 offen sc1
    v_cvt_pk_bf16_f32 v44, v71, v87
    v_cvt_pk_bf16_f32 v45, v103, v119
    v_cvt_pk_bf16_f32 v46, v135, v151
    v_cvt_pk_bf16_f32 v47, v167, v183
    s_add_u32 s54, s53, 720896
    buffer_store_dwordx4 v[44:47], v24, s[36:39], s54 offen sc1
    v_cvt_pk_bf16_f32 v32, v72, v88
    v_cvt_pk_bf16_f32 v33, v104, v120
    v_cvt_pk_bf16_f32 v34, v136, v152
    v_cvt_pk_bf16_f32 v35, v168, v184
    s_add_u32 s54, s53, 1048576
    buffer_store_dwordx4 v[32:35], v24, s[36:39], s54 offen sc1
    v_cvt_pk_bf16_f32 v36, v73, v89
    v_cvt_pk_bf16_f32 v37, v105, v121
    v_cvt_pk_bf16_f32 v38, v137, v153
    v_cvt_pk_bf16_f32 v39, v169, v185
    s_add_u32 s54, s53, 1114112
    buffer_store_dwordx4 v[36:39], v24, s[36:39], s54 offen sc1
    v_cvt_pk_bf16_f32 v40, v74, v90
    v_cvt_pk_bf16_f32 v41, v106, v122
    v_cvt_pk_bf16_f32 v42, v138, v154
    v_cvt_pk_bf16_f32 v43, v170, v186
    s_add_u32 s54, s53, 1179648
    buffer_store_dwordx4 v[40:43], v24, s[36:39], s54 offen sc1
    v_cvt_pk_bf16_f32 v44, v75, v91
    v_cvt_pk_bf16_f32 v45, v107, v123
    v_cvt_pk_bf16_f32 v46, v139, v155
    v_cvt_pk_bf16_f32 v47, v171, v187
    s_add_u32 s54, s53, 1245184
    buffer_store_dwordx4 v[44:47], v24, s[36:39], s54 offen sc1
    v_cvt_pk_bf16_f32 v32, v76, v92
    v_cvt_pk_bf16_f32 v33, v108, v124
    v_cvt_pk_bf16_f32 v34, v140, v156
    v_cvt_pk_bf16_f32 v35, v172, v188
    s_add_u32 s54, s53, 1572864
    buffer_store_dwordx4 v[32:35], v24, s[36:39], s54 offen sc1
    v_cvt_pk_bf16_f32 v36, v77, v93
    v_cvt_pk_bf16_f32 v37, v109, v125
    v_cvt_pk_bf16_f32 v38, v141, v157
    v_cvt_pk_bf16_f32 v39, v173, v189
    s_add_u32 s54, s53, 1638400
    buffer_store_dwordx4 v[36:39], v24, s[36:39], s54 offen sc1
    v_cvt_pk_bf16_f32 v40, v78, v94
    v_cvt_pk_bf16_f32 v41, v110, v126
    v_cvt_pk_bf16_f32 v42, v142, v158
    v_cvt_pk_bf16_f32 v43, v174, v190
    s_add_u32 s54, s53, 1703936
    buffer_store_dwordx4 v[40:43], v24, s[36:39], s54 offen sc1
    v_cvt_pk_bf16_f32 v44, v79, v95
    v_cvt_pk_bf16_f32 v45, v111, v127
    v_cvt_pk_bf16_f32 v46, v143, v159
    v_cvt_pk_bf16_f32 v47, v175, v191
    s_add_u32 s54, s53, 1769472
    buffer_store_dwordx4 v[44:47], v24, s[36:39], s54 offen sc1
    v_mov_b32 v2, s47
    buffer_load_dword v3, v63, s[40:43], 0 offen sc1
    s_lshl_b32 s53, s3, 12
    s_add_u32 s6, s53, 0
    s_xor_b32 s9, s6, 4096
    s_add_u32 s7, s53, 16384
    s_xor_b32 s10, s7, 8192
    s_add_u32 s8, s53, 32768
    s_xor_b32 s11, s8, 12288
    s_lshr_b32 s12, s53, 1
    s_add_u32 s12, s12, 49152
    s_mov_b32 s36, s28
    s_mov_b32 s37, s29
    s_mov_b32 s38, 7340032
    s_mov_b32 s39, 0x20000
    s_add_u32 s32, s28, 8388608
    s_addc_u32 s33, s29, 0
    s_mov_b32 s34, 4194304
    s_mov_b32 s35, 0x20000
    s_mov_b32 s72, s24
    s_mov_b32 s73, s25
    s_mov_b32 s74, 2097152
    s_mov_b32 s75, 0x20000
    s_sub_u32 s62, 32, s71
    s_and_b32 s62, s62, 31
    s_cmp_lt_u32 s70, 4
    s_cselect_b32 s62, s71, s62
    s_lshl_b32 s62, s62, 16
    v_mov_b32 v185, 0
    v_mov_b32 v186, 0
    v_mov_b32 v187, 0
    v_mov_b32 v188, 0x3f80
    v_cmp_gt_u32 vcc, 32, v0
    v_mov_b32 v189, 0
    v_mov_b32 v190, 0
    v_cndmask_b32 v188, 0, v188, vcc
    v_mov_b32 v191, 0
    s_mul_i32 s57, s71, 112
    s_mul_i32 s53, s3, 28
    s_add_u32 s57, s57, s53
    s_lshl_b32 s57, s57, 11
    s_add_u32 s59, s57, 57344
    s_lshl_b32 s53, s44, 12
    s_add_u32 s58, s57, s53
    v_mov_b32 v2, s47
    s_mov_b32 s56, 262144
    v_lshl_add_u32 v10, v0, 4, s6
    v_lshl_add_u32 v11, v0, 4, s7
    v_lshl_add_u32 v12, v0, 4, s8
    v_mov_b32 v9, v62
    s_waitcnt vmcnt(0)
    s_waitcnt lgkmcnt(0)
    s_barrier
    buffer_store_dword v2, v58, s[40:43], 0 offen sc1
    v_mov_b32 v184, v254
    v_cmp_ne_u32 vcc, s47, v3
    s_cbranch_vccnz L_pslow_d
L_go_d:
    s_waitcnt lgkmcnt(0)
    s_mov_b32 s55, 0x80000
    buffer_load_dwordx4 v[16:19], v59, s[36:39], s58 offen offset:0 sc1
    buffer_load_dwordx4 v[20:23], v60, s[36:39], s58 offen offset:0 sc1
    buffer_load_dwordx4 v[24:27], v59, s[36:39], s58 offen offset:2048 sc1
    buffer_load_dwordx4 v[28:31], v60, s[36:39], s58 offen offset:2048 sc1
    s_add_u32 s58, s58, 4096
    s_cmp_eq_u32 s58, s59
    s_cselect_b32 s58, s57, s58
    buffer_load_dwordx4 v[32:35], v59, s[36:39], s58 offen offset:0 sc1
    buffer_load_dwordx4 v[36:39], v60, s[36:39], s58 offen offset:0 sc1
    buffer_load_dwordx4 v[40:43], v59, s[36:39], s58 offen offset:2048 sc1
    buffer_load_dwordx4 v[44:47], v60, s[36:39], s58 offen offset:2048 sc1
    s_add_u32 s58, s58, 4096
    s_cmp_eq_u32 s58, s59
    s_cselect_b32 s58, s57, s58
    buffer_load_dwordx4 v[48:51], v59, s[36:39], s58 offen offset:0 sc1
    buffer_load_dwordx4 v[52:55], v60, s[36:39], s58 offen offset:0 sc1
    buffer_load_dwordx4 v[192:195], v59, s[36:39], s58 offen offset:2048 sc1
    buffer_load_dwordx4 v[196:199], v60, s[36:39], s58 offen offset:2048 sc1
    s_add_u32 s58, s58, 4096
    s_cmp_eq_u32 s58, s59
    s_cselect_b32 s58, s57, s58
    buffer_load_dwordx4 v[200:203], v59, s[36:39], s58 offen offset:0 sc1
    buffer_load_dwordx4 v[204:207], v60, s[36:39], s58 offen offset:0 sc1
    buffer_load_dwordx4 v[208:211], v59, s[36:39], s58 offen offset:2048 sc1
    buffer_load_dwordx4 v[212:215], v60, s[36:39], s58 offen offset:2048 sc1
    s_add_u32 s58, s58, 4096
    s_cmp_eq_u32 s58, s59
    s_cselect_b32 s58, s57, s58
    v_mfma_f32_32x32x16_bf16 v[64:79], v[184:187], v[188:191], 0
    s_waitcnt vmcnt(14)
    v_mfma_f32_32x32x16_bf16 v[64:79], a[0:3], v[16:19], v[64:79]
    v_and_b32 v236, 31, v0
    v_lshrrev_b32 v237, 5, v0
    v_lshlrev_b32 v237, 3, v237
    v_lshl_add_u32 v237, v236, 6, v237
    v_mfma_f32_32x32x16_bf16 v[80:95], a[4:7], v[16:19], 0
    v_bfe_u32 v236, v0, 2, 2
    v_lshl_add_u32 v236, v236, 4, v237
    v_add_u32 v236, s12, v236
    v_xor_b32 v237, 16, v236
    v_mfma_f32_32x32x16_bf16 v[96:111], a[0:3], v[20:23], 0
    v_xor_b32 v238, 32, v236
    v_xor_b32 v239, 48, v236
    v_lshl_add_u32 v240, v0, 4, s12
    s_cmp_lt_u32 s70, 4
    s_cselect_b32 s0, 0, 0x80000000
    v_mfma_f32_32x32x16_bf16 v[112:127], a[4:7], v[20:23], 0
    buffer_load_dwordx4 v[216:219], v59, s[36:39], s58 offen offset:0 sc1
    buffer_load_dwordx4 v[220:223], v60, s[36:39], s58 offen offset:0 sc1
    s_waitcnt vmcnt(14)
    v_mfma_f32_32x32x16_bf16 v[64:79], a[8:11], v[24:27], v[64:79]
    ds_read_b64_tr_b16 a[160:161], v243 offset:0
    ds_read_b64_tr_b16 a[162:163], v243 offset:1024
    ds_read_b64_tr_b16 a[164:165], v244 offset:0
    ds_read_b64_tr_b16 a[166:167], v244 offset:1024
    v_mfma_f32_32x32x16_bf16 v[80:95], a[12:15], v[24:27], v[80:95]
    s_or_b32 s0, s0, 0x3a000000
    v_mov_b32 v13, v245
    v_lshrrev_b32 v14, 5, v0
    v_cvt_f32_u32 v13, v13
    v_mfma_f32_32x32x16_bf16 v[96:111], a[8:11], v[28:31], v[96:111]
    v_cvt_f32_u32 v14, v14
    v_mul_f32 v13, s0, v13
    v_cmp_gt_u32 s[0:1], 32, v0
    v_mul_f32 v14, v14, v13
    v_mfma_f32_32x32x16_bf16 v[112:127], a[12:15], v[28:31], v[112:127]
    buffer_load_dwordx4 v[224:227], v59, s[36:39], s58 offen offset:2048 sc1
    buffer_load_dwordx4 v[228:231], v60, s[36:39], s58 offen offset:2048 sc1
    s_add_u32 s58, s58, 4096
    s_cmp_eq_u32 s58, s59
    s_cselect_b32 s58, s57, s58
    s_waitcnt vmcnt(14)
    v_mfma_f32_32x32x16_bf16 v[64:79], a[16:19], v[32:35], v[64:79]
    ds_read_b64_tr_b16 a[168:169], v243 offset:2048
    ds_read_b64_tr_b16 a[170:171], v243 offset:3072
    ds_read_b64_tr_b16 a[172:173], v244 offset:2048
    ds_read_b64_tr_b16 a[174:175], v244 offset:3072
    v_mfma_f32_32x32x16_bf16 v[80:95], a[20:23], v[32:35], v[80:95]
    v_mul_f32 v15, 0x42000000, v13
    v_add_f32 v13, v13, v13
    v_mul_f32 v8, 0.5, v15
    v_cndmask_b32 v8, v15, v8, s[0:1]
    v_mfma_f32_32x32x16_bf16 v[96:111], a[16:19], v[36:39], v[96:111]
    v_add_f32 v5, v14, v15
    v_sub_f32 v6, v8, v14
    v_add_f32 v7, v6, v15
    v_cos_f32 v128, v14
    v_mfma_f32_32x32x16_bf16 v[112:127], a[20:23], v[36:39], v[112:127]
    buffer_load_dwordx4 v[16:19], v59, s[36:39], s58 offen offset:0 sc1
    buffer_load_dwordx4 v[20:23], v60, s[36:39], s58 offen offset:0 sc1
    s_mov_b32 m0, s12
    s_nop 0
    buffer_load_dwordx4 v255, s[76:79], 0 offen lds
    s_add_u32 m0, m0, 1024
    s_nop 0
    buffer_load_dwordx4 v255, s[76:79], s55 offen lds
    s_waitcnt vmcnt(16)
    v_mfma_f32_32x32x16_bf16 v[64:79], a[24:27], v[40:43], v[64:79]
    ds_read_b64_tr_b16 a[176:177], v243 offset:4096
    ds_read_b64_tr_b16 a[178:179], v243 offset:5120
    ds_read_b64_tr_b16 a[180:181], v244 offset:4096
    ds_read_b64_tr_b16 a[182:183], v244 offset:5120
    v_mfma_f32_32x32x16_bf16 v[80:95], a[28:31], v[40:43], v[80:95]
    v_sin_f32 v129, v14
    v_cos_f32 v130, v5
    v_mfma_f32_32x32x16_bf16 v[96:111], a[24:27], v[44:47], v[96:111]
    v_sin_f32 v131, v5
    v_cos_f32 v132, v6
    v_mfma_f32_32x32x16_bf16 v[112:127], a[28:31], v[44:47], v[112:127]
    buffer_load_dwordx4 v[24:27], v59, s[36:39], s58 offen offset:2048 sc1
    buffer_load_dwordx4 v[28:31], v60, s[36:39], s58 offen offset:2048 sc1
    s_add_u32 s58, s58, 4096
    s_cmp_eq_u32 s58, s59
    s_cselect_b32 s58, s57, s58
    s_waitcnt vmcnt(16)
    v_mfma_f32_32x32x16_bf16 v[64:79], a[32:35], v[48:51], v[64:79]
    ds_read_b64_tr_b16 a[184:185], v243 offset:6144
    ds_read_b64_tr_b16 a[186:187], v243 offset:7168
    ds_read_b64_tr_b16 a[188:189], v244 offset:6144
    ds_read_b64_tr_b16 a[190:191], v244 offset:7168
    v_mfma_f32_32x32x16_bf16 v[80:95], a[36:39], v[48:51], v[80:95]
    v_sin_f32 v133, v6
    v_cos_f32 v134, v7
    v_mfma_f32_32x32x16_bf16 v[96:111], a[32:35], v[52:55], v[96:111]
    v_sin_f32 v135, v7
    v_cvt_pk_bf16_f32 v232, v128, v129
    v_cvt_pk_bf16_f32 v233, v130, v131
    v_mfma_f32_32x32x16_bf16 v[112:127], a[36:39], v[52:55], v[112:127]
    buffer_load_dwordx4 v[32:35], v59, s[36:39], s58 offen offset:0 sc1
    buffer_load_dwordx4 v[36:39], v60, s[36:39], s58 offen offset:0 sc1
    s_waitcnt vmcnt(16)
    v_mfma_f32_32x32x16_bf16 v[64:79], a[40:43], v[192:195], v[64:79]
    ds_read_b64_tr_b16 a[192:193], v241 offset:0
    ds_read_b64_tr_b16 a[194:195], v241 offset:1024
    ds_read_b64_tr_b16 a[196:197], v242 offset:0
    ds_read_b64_tr_b16 a[198:199], v242 offset:1024
    v_mfma_f32_32x32x16_bf16 v[80:95], a[44:47], v[192:195], v[80:95]
    v_cvt_pk_bf16_f32 v234, v132, v133
    v_cvt_pk_bf16_f32 v235, v134, v135
    v_accvgpr_write_b32 a224, v232
    v_accvgpr_write_b32 a225, v233
    v_mfma_f32_32x32x16_bf16 v[96:111], a[40:43], v[196:199], v[96:111]
    v_accvgpr_write_b32 a226, v234
    v_accvgpr_write_b32 a227, v235
    v_add_f32 v14, v14, v13
    v_add_f32 v5, v14, v15
    v_mfma_f32_32x32x16_bf16 v[112:127], a[44:47], v[196:199], v[112:127]
    buffer_load_dwordx4 v[40:43], v59, s[36:39], s58 offen offset:2048 sc1
    buffer_load_dwordx4 v[44:47], v60, s[36:39], s58 offen offset:2048 sc1
    s_add_u32 s58, s58, 4096
    s_cmp_eq_u32 s58, s59
    s_cselect_b32 s58, s57, s58
    s_waitcnt vmcnt(16)
    v_mfma_f32_32x32x16_bf16 v[64:79], a[48:51], v[200:203], v[64:79]
    ds_read_b64_tr_b16 a[200:201], v241 offset:2048
    ds_read_b64_tr_b16 a[202:203], v241 offset:3072
    ds_read_b64_tr_b16 a[204:205], v242 offset:2048
    ds_read_b64_tr_b16 a[206:207], v242 offset:3072
    v_mfma_f32_32x32x16_bf16 v[80:95], a[52:55], v[200:203], v[80:95]
    v_sub_f32 v6, v15, v14
    v_add_f32 v7, v6, v15
    v_cos_f32 v128, v14
    v_mfma_f32_32x32x16_bf16 v[96:111], a[48:51], v[204:207], v[96:111]
    v_sin_f32 v129, v14
    v_cos_f32 v130, v5
    v_mfma_f32_32x32x16_bf16 v[112:127], a[52:55], v[204:207], v[112:127]
    buffer_load_dwordx4 v[48:51], v59, s[36:39], s58 offen offset:0 sc1
    buffer_load_dwordx4 v[52:55], v60, s[36:39], s58 offen offset:0 sc1
    s_waitcnt vmcnt(16)
    v_mfma_f32_32x32x16_bf16 v[64:79], a[56:59], v[208:211], v[64:79]
    ds_read_b64_tr_b16 a[208:209], v241 offset:4096
    ds_read_b64_tr_b16 a[210:211], v241 offset:5120
    ds_read_b64_tr_b16 a[212:213], v242 offset:4096
    ds_read_b64_tr_b16 a[214:215], v242 offset:5120
    v_mfma_f32_32x32x16_bf16 v[80:95], a[60:63], v[208:211], v[80:95]
    v_sin_f32 v131, v5
    v_cos_f32 v132, v6
    v_mfma_f32_32x32x16_bf16 v[96:111], a[56:59], v[212:215], v[96:111]
    v_sin_f32 v133, v6
    v_cos_f32 v134, v7
    v_mfma_f32_32x32x16_bf16 v[112:127], a[60:63], v[212:215], v[112:127]
    buffer_load_dwordx4 v[192:195], v59, s[36:39], s58 offen offset:2048 sc1
    buffer_load_dwordx4 v[196:199], v60, s[36:39], s58 offen offset:2048 sc1
    s_add_u32 s58, s58, 4096
    s_cmp_eq_u32 s58, s59
    s_cselect_b32 s58, s57, s58
    s_waitcnt vmcnt(16)
    v_mfma_f32_32x32x16_bf16 v[64:79], a[64:67], v[216:219], v[64:79]
    ds_read_b64_tr_b16 a[216:217], v241 offset:6144
    ds_read_b64_tr_b16 a[218:219], v241 offset:7168
    ds_read_b64_tr_b16 a[220:221], v242 offset:6144
    ds_read_b64_tr_b16 a[222:223], v242 offset:7168
    v_mfma_f32_32x32x16_bf16 v[80:95], a[68:71], v[216:219], v[80:95]
    v_sin_f32 v135, v7
    v_cvt_pk_bf16_f32 v232, v128, v129
    v_cvt_pk_bf16_f32 v233, v130, v131
    v_mfma_f32_32x32x16_bf16 v[96:111], a[64:67], v[220:223], v[96:111]
    v_cvt_pk_bf16_f32 v234, v132, v133
    v_cvt_pk_bf16_f32 v235, v134, v135
    v_accvgpr_write_b32 a228, v232
    v_accvgpr_write_b32 a229, v233
    v_mfma_f32_32x32x16_bf16 v[112:127], a[68:71], v[220:223], v[112:127]
    buffer_load_dwordx4 v[200:203], v59, s[36:39], s58 offen offset:0 sc1
    buffer_load_dwordx4 v[204:207], v60, s[36:39], s58 offen offset:0 sc1
    s_waitcnt vmcnt(16)
    v_mfma_f32_32x32x16_bf16 v[64:79], a[72:75], v[224:227], v[64:79]
    v_accvgpr_write_b32 a230, v234
    v_accvgpr_write_b32 a231, v235
    v_add_f32 v14, v14, v13
    v_add_f32 v5, v14, v15
    v_mfma_f32_32x32x16_bf16 v[80:95], a[76:79], v[224:227], v[80:95]
    v_sub_f32 v6, v15, v14
    v_add_f32 v7, v6, v15
    v_cos_f32 v128, v14
    v_mfma_f32_32x32x16_bf16 v[96:111], a[72:75], v[228:231], v[96:111]
    v_sin_f32 v129, v14
    v_cos_f32 v130, v5
    v_mfma_f32_32x32x16_bf16 v[112:127], a[76:79], v[228:231], v[112:127]
    buffer_load_dwordx4 v[208:211], v59, s[36:39], s58 offen offset:2048 sc1
    buffer_load_dwordx4 v[212:215], v60, s[36:39], s58 offen offset:2048 sc1
    s_add_u32 s58, s58, 4096
    s_cmp_eq_u32 s58, s59
    s_cselect_b32 s58, s57, s58
    s_waitcnt vmcnt(16)
    v_mfma_f32_32x32x16_bf16 v[64:79], a[80:83], v[16:19], v[64:79]
    v_sin_f32 v131, v5
    v_cos_f32 v132, v6
    v_mfma_f32_32x32x16_bf16 v[80:95], a[84:87], v[16:19], v[80:95]
    v_sin_f32 v133, v6
    v_cos_f32 v134, v7
    v_mfma_f32_32x32x16_bf16 v[96:111], a[80:83], v[20:23], v[96:111]
    v_sin_f32 v135, v7
    v_cvt_pk_bf16_f32 v232, v128, v129
    v_cvt_pk_bf16_f32 v233, v130, v131
    v_mfma_f32_32x32x16_bf16 v[112:127], a[84:87], v[20:23], v[112:127]
    buffer_load_dwordx4 v[216:219], v59, s[36:39], s58 offen offset:0 sc1
    buffer_load_dwordx4 v[220:223], v60, s[36:39], s58 offen offset:0 sc1
    s_waitcnt vmcnt(14)
    v_mfma_f32_32x32x16_bf16 v[64:79], a[88:91], v[24:27], v[64:79]
    v_cvt_pk_bf16_f32 v234, v132, v133
    v_cvt_pk_bf16_f32 v235, v134, v135
    v_accvgpr_write_b32 a232, v232
    v_accvgpr_write_b32 a233, v233
    v_mfma_f32_32x32x16_bf16 v[80:95], a[92:95], v[24:27], v[80:95]
    v_accvgpr_write_b32 a234, v234
    v_accvgpr_write_b32 a235, v235
    v_add_f32 v14, v14, v13
    v_add_f32 v5, v14, v15
    v_mfma_f32_32x32x16_bf16 v[96:111], a[88:91], v[28:31], v[96:111]
    v_sub_f32 v6, v15, v14
    v_add_f32 v7, v6, v15
    v_cos_f32 v128, v14
    v_mfma_f32_32x32x16_bf16 v[112:127], a[92:95], v[28:31], v[112:127]
    buffer_load_dwordx4 v[224:227], v59, s[36:39], s58 offen offset:2048 sc1
    buffer_load_dwordx4 v[228:231], v60, s[36:39], s58 offen offset:2048 sc1
    s_add_u32 s58, s58, 4096
    s_cmp_eq_u32 s58, s59
    s_cselect_b32 s58, s57, s58
    buffer_load_dword v176, v9, s[40:43], 0 offen sc1
    s_waitcnt vmcnt(15)
    v_mfma_f32_32x32x16_bf16 v[64:79], a[96:99], v[32:35], v[64:79]
    v_sin_f32 v129, v14
    v_cos_f32 v130, v5
    v_mfma_f32_32x32x16_bf16 v[80:95], a[100:103], v[32:35], v[80:95]
    v_sin_f32 v131, v5
    v_cos_f32 v132, v6
    v_mfma_f32_32x32x16_bf16 v[96:111], a[96:99], v[36:39], v[96:111]
    v_sin_f32 v133, v6
    v_cos_f32 v134, v7
    v_mfma_f32_32x32x16_bf16 v[112:127], a[100:103], v[36:39], v[112:127]
    buffer_load_dwordx4 v[16:19], v59, s[36:39], s58 offen offset:0 sc1
    buffer_load_dwordx4 v[20:23], v60, s[36:39], s58 offen offset:0 sc1
    s_waitcnt vmcnt(15)
    v_mfma_f32_32x32x16_bf16 v[64:79], a[104:107], v[40:43], v[64:79]
    v_sin_f32 v135, v7
    v_cvt_pk_bf16_f32 v232, v128, v129
    v_cvt_pk_bf16_f32 v233, v130, v131
    v_mfma_f32_32x32x16_bf16 v[80:95], a[108:111], v[40:43], v[80:95]
    v_cvt_pk_bf16_f32 v234, v132, v133
    v_cvt_pk_bf16_f32 v235, v134, v135
    v_accvgpr_write_b32 a236, v232
    v_accvgpr_write_b32 a237, v233
    v_mfma_f32_32x32x16_bf16 v[96:111], a[104:107], v[44:47], v[96:111]
    v_accvgpr_write_b32 a238, v234
    v_accvgpr_write_b32 a239, v235
    v_add_f32 v14, v14, v13
    v_add_f32 v5, v14, v15
    v_mfma_f32_32x32x16_bf16 v[112:127], a[108:111], v[44:47], v[112:127]
    buffer_load_dwordx4 v[24:27], v59, s[36:39], s58 offen offset:2048 sc1
    buffer_load_dwordx4 v[28:31], v60, s[36:39], s58 offen offset:2048 sc1
    s_add_u32 s58, s58, 4096
    s_cmp_eq_u32 s58, s59
    s_cselect_b32 s58, s57, s58
    s_waitcnt vmcnt(15)
    v_mfma_f32_32x32x16_bf16 v[64:79], a[112:115], v[48:51], v[64:79]
    v_sub_f32 v6, v15, v14
    v_add_f32 v7, v6, v15
    v_cos_f32 v128, v14
    v_mfma_f32_32x32x16_bf16 v[80:95], a[116:119], v[48:51], v[80:95]
    v_sin_f32 v129, v14
    v_cos_f32 v130, v5
    v_mfma_f32_32x32x16_bf16 v[96:111], a[112:115], v[52:55], v[96:111]
    v_sin_f32 v131, v5
    v_cos_f32 v132, v6
    v_mfma_f32_32x32x16_bf16 v[112:127], a[116:119], v[52:55], v[112:127]
    buffer_load_dwordx4 v[32:35], v59, s[36:39], s58 offen offset:0 sc1
    buffer_load_dwordx4 v[36:39], v60, s[36:39], s58 offen offset:0 sc1
    s_waitcnt vmcnt(15)
    v_mfma_f32_32x32x16_bf16 v[64:79], a[120:123], v[192:195], v[64:79]
    v_sin_f32 v133, v6
    v_cos_f32 v134, v7
    v_mfma_f32_32x32x16_bf16 v[80:95], a[124:127], v[192:195], v[80:95]
    v_sin_f32 v135, v7
    v_cvt_pk_bf16_f32 v232, v128, v129
    v_cvt_pk_bf16_f32 v233, v130, v131
    v_mfma_f32_32x32x16_bf16 v[96:111], a[120:123], v[196:199], v[96:111]
    v_cvt_pk_bf16_f32 v234, v132, v133
    v_cvt_pk_bf16_f32 v235, v134, v135
    v_accvgpr_write_b32 a240, v232
    v_accvgpr_write_b32 a241, v233
    v_mfma_f32_32x32x16_bf16 v[112:127], a[124:127], v[196:199], v[112:127]
    buffer_load_dwordx4 v[40:43], v59, s[36:39], s58 offen offset:2048 sc1
    buffer_load_dwordx4 v[44:47], v60, s[36:39], s58 offen offset:2048 sc1
    s_add_u32 s58, s58, 4096
    s_cmp_eq_u32 s58, s59
    s_cselect_b32 s58, s57, s58
    s_waitcnt vmcnt(15)
    s_waitcnt lgkmcnt(0)
    v_mfma_f32_32x32x16_bf16 v[64:79], a[128:131], v[200:203], v[64:79]
    v_accvgpr_write_b32 a242, v234
    v_accvgpr_write_b32 a243, v235
    v_add_f32 v14, v14, v13
    v_add_f32 v5, v14, v15
    v_mfma_f32_32x32x16_bf16 v[80:95], a[132:135], v[200:203], v[80:95]
    v_sub_f32 v6, v15, v14
    v_add_f32 v7, v6, v15
    v_cos_f32 v128, v14
    v_mfma_f32_32x32x16_bf16 v[96:111], a[128:131], v[204:207], v[96:111]
    v_sin_f32 v129, v14
    v_cos_f32 v130, v5
    v_mfma_f32_32x32x16_bf16 v[112:127], a[132:135], v[204:207], v[112:127]
    buffer_load_dwordx4 v[48:51], v59, s[36:39], s58 offen offset:0 sc1
    buffer_load_dwordx4 v[52:55], v60, s[36:39], s58 offen offset:0 sc1
    s_waitcnt vmcnt(15)
    v_mfma_f32_32x32x16_bf16 v[64:79], a[136:139], v[208:211], v[64:79]
    v_sin_f32 v131, v5
    v_cos_f32 v132, v6
    v_mfma_f32_32x32x16_bf16 v[80:95], a[140:143], v[208:211], v[80:95]
    v_sin_f32 v133, v6
    v_cos_f32 v134, v7
    v_mfma_f32_32x32x16_bf16 v[96:111], a[136:139], v[212:215], v[96:111]
    v_sin_f32 v135, v7
    v_cvt_pk_bf16_f32 v232, v128, v129
    v_cvt_pk_bf16_f32 v233, v130, v131
    v_mfma_f32_32x32x16_bf16 v[112:127], a[140:143], v[212:215], v[112:127]
    buffer_load_dwordx4 v[192:195], v59, s[36:39], s58 offen offset:2048 sc1
    buffer_load_dwordx4 v[196:199], v60, s[36:39], s58 offen offset:2048 sc1
    s_add_u32 s58, s58, 4096
    s_cmp_eq_u32 s58, s59
    s_cselect_b32 s58, s57, s58
    s_waitcnt vmcnt(15)
    v_mfma_f32_32x32x16_bf16 v[64:79], a[144:147], v[216:219], v[64:79]
    v_cvt_pk_bf16_f32 v234, v132, v133
    v_cvt_pk_bf16_f32 v235, v134, v135
    v_accvgpr_write_b32 a244, v232
    v_accvgpr_write_b32 a245, v233
    v_mfma_f32_32x32x16_bf16 v[80:95], a[148:151], v[216:219], v[80:95]
    v_accvgpr_write_b32 a246, v234
    v_accvgpr_write_b32 a247, v235
    v_add_f32 v14, v14, v13
    v_add_f32 v5, v14, v15
    v_mfma_f32_32x32x16_bf16 v[96:111], a[144:147], v[220:223], v[96:111]
    v_sub_f32 v6, v15, v14
    v_add_f32 v7, v6, v15
    v_cos_f32 v128, v14
    v_mfma_f32_32x32x16_bf16 v[112:127], a[148:151], v[220:223], v[112:127]
    buffer_load_dwordx4 v[200:203], v59, s[36:39], s58 offen offset:0 sc1
    buffer_load_dwordx4 v[204:207], v60, s[36:39], s58 offen offset:0 sc1
    s_waitcnt vmcnt(15)
    v_mfma_f32_32x32x16_bf16 v[64:79], a[152:155], v[224:227], v[64:79]
    v_sin_f32 v129, v14
    v_cos_f32 v130, v5
    v_mfma_f32_32x32x16_bf16 v[80:95], a[156:159], v[224:227], v[80:95]
    v_sin_f32 v131, v5
    v_cos_f32 v132, v6
    v_mfma_f32_32x32x16_bf16 v[96:111], a[152:155], v[228:231], v[96:111]
    v_sin_f32 v133, v6
    v_cos_f32 v134, v7
    v_mfma_f32_32x32x16_bf16 v[112:127], a[156:159], v[228:231], v[112:127]
    buffer_load_dwordx4 v[208:211], v59, s[36:39], s58 offen offset:2048 sc1
    buffer_load_dwordx4 v[212:215], v60, s[36:39], s58 offen offset:2048 sc1
    s_waitcnt vmcnt(14)
    v_mfma_f32_32x32x16_bf16 v[64:79], a[160:163], v[16:19], v[64:79]
    v_sin_f32 v135, v7
    v_cvt_pk_bf16_f32 v232, v128, v129
    v_cvt_pk_bf16_f32 v233, v130, v131
    v_mfma_f32_32x32x16_bf16 v[80:95], a[164:167], v[16:19], v[80:95]
    v_cvt_pk_bf16_f32 v234, v132, v133
    v_cvt_pk_bf16_f32 v235, v134, v135
    v_accvgpr_write_b32 a248, v232
    v_accvgpr_write_b32 a249, v233
    v_mfma_f32_32x32x16_bf16 v[96:111], a[160:163], v[20:23], v[96:111]
    v_accvgpr_write_b32 a250, v234
    v_accvgpr_write_b32 a251, v235
    v_add_f32 v14, v14, v13
    v_add_f32 v5, v14, v15
    v_mfma_f32_32x32x16_bf16 v[112:127], a[164:167], v[20:23], v[112:127]
L_chk_d:
    v_cmp_ne_u32 vcc, s47, v176
    s_cbranch_vccnz L_uslow_d
L_allset_d:
    s_waitcnt vmcnt(12)
    v_mfma_f32_32x32x16_bf16 v[64:79], a[168:171], v[24:27], v[64:79]
    v_sub_f32 v6, v15, v14
    v_add_f32 v7, v6, v15
    v_cos_f32 v128, v14
    v_mfma_f32_32x32x16_bf16 v[80:95], a[172:175], v[24:27], v[80:95]
    v_sin_f32 v129, v14
    v_cos_f32 v130, v5
    s_add_u32 s53, s62, 0
    buffer_load_dwordx4 v[144:147], v61, s[32:35], s53 offen sc1
    v_mfma_f32_32x32x16_bf16 v[96:111], a[168:171], v[28:31], v[96:111]
    v_sin_f32 v131, v5
    v_cos_f32 v132, v6
    v_mfma_f32_32x32x16_bf16 v[112:127], a[172:175], v[28:31], v[112:127]
    s_add_u32 s53, s62, 8192
    buffer_load_dwordx4 v[148:151], v61, s[32:35], s53 offen sc1
    s_waitcnt vmcnt(12)
    v_mfma_f32_32x32x16_bf16 v[64:79], a[176:179], v[32:35], v[64:79]
    v_sin_f32 v133, v6
    v_cos_f32 v134, v7
    v_mfma_f32_32x32x16_bf16 v[80:95], a[180:183], v[32:35], v[80:95]
    v_sin_f32 v135, v7
    v_cvt_pk_bf16_f32 v232, v128, v129
    v_cvt_pk_bf16_f32 v233, v130, v131
    s_add_u32 s53, s62, 16384
    buffer_load_dwordx4 v[152:155], v61, s[32:35], s53 offen sc1
    v_mfma_f32_32x32x16_bf16 v[96:111], a[176:179], v[36:39], v[96:111]
    v_cvt_pk_bf16_f32 v234, v132, v133
    v_cvt_pk_bf16_f32 v235, v134, v135
    v_accvgpr_write_b32 a252, v232
    v_accvgpr_write_b32 a253, v233
    v_mfma_f32_32x32x16_bf16 v[112:127], a[180:183], v[36:39], v[112:127]
    s_add_u32 s53, s62, 24576
    buffer_load_dwordx4 v[156:159], v61, s[32:35], s53 offen sc1
    ds_read_b64 v[246:247], v236
    ds_read_b64 v[248:249], v237
    ds_read_b64 v[250:251], v238
    ds_read_b64 v[252:253], v239
    s_waitcnt vmcnt(12)
    v_mfma_f32_32x32x16_bf16 v[64:79], a[184:187], v[40:43], v[64:79]
    v_accvgpr_write_b32 a254, v234
    v_accvgpr_write_b32 a255, v235
    v_mfma_f32_32x32x16_bf16 v[80:95], a[188:191], v[40:43], v[80:95]
    s_add_u32 s53, s62, 32768
    buffer_load_dwordx4 v[160:163], v61, s[32:35], s53 offen sc1
    v_mfma_f32_32x32x16_bf16 v[96:111], a[184:187], v[44:47], v[96:111]
    v_mfma_f32_32x32x16_bf16 v[112:127], a[188:191], v[44:47], v[112:127]
    s_add_u32 s53, s62, 40960
    buffer_load_dwordx4 v[164:167], v61, s[32:35], s53 offen sc1
    s_waitcnt vmcnt(12)
    v_mfma_f32_32x32x16_bf16 v[64:79], a[192:195], v[48:51], v[64:79]
    v_mfma_f32_32x32x16_bf16 v[80:95], a[196:199], v[48:51], v[80:95]
    s_add_u32 s53, s62, 49152
    buffer_load_dwordx4 v[168:171], v61, s[32:35], s53 offen sc1
    v_mfma_f32_32x32x16_bf16 v[96:111], a[192:195], v[52:55], v[96:111]
    v_mfma_f32_32x32x16_bf16 v[112:127], a[196:199], v[52:55], v[112:127]
    s_add_u32 s53, s62, 57344
    buffer_load_dwordx4 v[172:175], v61, s[32:35], s53 offen sc1
    s_waitcnt vmcnt(12)
    v_mfma_f32_32x32x16_bf16 v[112:127], a[204:207], v[196:199], v[112:127]
    s_mov_b32 s63, 0xffff0000
    s_waitcnt vmcnt(10)
    v_mfma_f32_32x32x16_bf16 v[112:127], a[212:215], v[204:207], v[112:127]
    s_waitcnt vmcnt(8)
    v_mfma_f32_32x32x16_bf16 v[112:127], a[220:223], v[212:215], v[112:127]
    s_waitcnt lgkmcnt(0)
    v_lshlrev_b32 v176, 16, v246
    v_and_b32 v177, s63, v246
    v_lshlrev_b32 v178, 16, v247
    v_mfma_f32_32x32x16_bf16 v[96:111], a[200:203], v[196:199], v[96:111]
    v_and_b32 v179, s63, v247
    v_lshlrev_b32 v180, 16, v248
    v_and_b32 v181, s63, v248
    v_lshlrev_b32 v182, 16, v249
    v_and_b32 v183, s63, v249
    v_mfma_f32_32x32x16_bf16 v[96:111], a[208:211], v[204:207], v[96:111]
    v_lshlrev_b32 v184, 16, v250
    v_and_b32 v185, s63, v250
    v_lshlrev_b32 v186, 16, v251
    v_and_b32 v187, s63, v251
    v_mfma_f32_32x32x16_bf16 v[96:111], a[216:219], v[212:215], v[96:111]
    v_lshlrev_b32 v188, 16, v252
    v_and_b32 v189, s63, v252
    v_lshlrev_b32 v190, 16, v253
    v_and_b32 v191, s63, v253
    v_mfma_f32_32x32x16_bf16 v[80:95], a[204:207], v[192:195], v[80:95]
    ds_write_b128 v12, v[112:115] offset:0
    ds_write_b128 v12, v[116:119] offset:1024
    v_mfma_f32_32x32x16_bf16 v[80:95], a[212:215], v[200:203], v[80:95]
    ds_write_b128 v12, v[120:123] offset:2048
    ds_write_b128 v12, v[124:127] offset:3072
    v_mfma_f32_32x32x16_bf16 v[80:95], a[220:223], v[208:211], v[80:95]
    s_mov_b32 s60, 0xbfb8aa3b
    s_mov_b32 s61, s60
    s_mov_b32 s62, 1.0
    s_mov_b32 s63, 1.0
    v_mfma_f32_32x32x16_bf16 v[64:79], a[200:203], v[192:195], v[64:79]
    v_mfma_f32_32x32x16_bf16 v[64:79], a[208:211], v[200:203], v[64:79]
    ds_write_b128 v11, v[96:99] offset:0
    ds_write_b128 v11, v[100:103] offset:1024
    v_mfma_f32_32x32x16_bf16 v[64:79], a[216:219], v[208:211], v[64:79]
    ds_write_b128 v11, v[104:107] offset:2048
    ds_write_b128 v11, v[108:111] offset:3072
    s_waitcnt vmcnt(0)
    v_mfma_f32_32x32x16_bf16 v[128:143], v[144:147], a[224:227], 0
    ds_write_b128 v10, v[80:83] offset:0
    ds_write_b128 v10, v[84:87] offset:1024
    v_mfma_f32_32x32x16_bf16 v[128:143], v[148:151], a[228:231], v[128:143]
    ds_write_b128 v10, v[88:91] offset:2048
    ds_write_b128 v10, v[92:95] offset:3072
    v_mfma_f32_32x32x16_bf16 v[128:143], v[152:155], a[232:235], v[128:143]
    v_lshl_add_u32 v10, v0, 4, s9
    v_lshl_add_u32 v11, v0, 4, s10
    v_lshl_add_u32 v12, v0, 4, s11
    s_waitcnt lgkmcnt(0)
    s_barrier
    v_mfma_f32_32x32x16_bf16 v[128:143], v[156:159], a[236:239], v[128:143]
    ds_read_b128 v[192:195], v10 offset:0
    ds_read_b128 v[208:211], v11 offset:0
    ds_read_b128 v[16:19], v12 offset:0
    ds_read_b128 v[196:199], v10 offset:1024
    v_mfma_f32_32x32x16_bf16 v[128:143], v[160:163], a[240:243], v[128:143]
    ds_read_b128 v[212:215], v11 offset:1024
    ds_read_b128 v[20:23], v12 offset:1024
    ds_read_b128 v[200:203], v10 offset:2048
    ds_read_b128 v[216:219], v11 offset:2048
    v_mfma_f32_32x32x16_bf16 v[128:143], v[164:167], a[244:247], v[128:143]
    ds_read_b128 v[24:27], v12 offset:2048
    ds_read_b128 v[204:207], v10 offset:3072
    ds_read_b128 v[220:223], v11 offset:3072
    ds_read_b128 v[28:31], v12 offset:3072
    v_mfma_f32_32x32x16_bf16 v[128:143], v[168:171], a[248:251], v[128:143]
    v_mfma_f32_32x32x16_bf16 v[128:143], v[172:175], a[252:255], v[128:143]
    s_waitcnt lgkmcnt(6)
    v_pk_add_f32 v[192:193], v[192:193], v[208:209]
    v_pk_add_f32 v[194:195], v[194:195], v[210:211]
    v_pk_add_f32 v[196:197], v[196:197], v[212:213]
    v_pk_add_f32 v[198:199], v[198:199], v[214:215]
    v_pk_add_f32 v[64:65], v[64:65], v[16:17]
    v_pk_add_f32 v[66:67], v[66:67], v[18:19]
    v_pk_add_f32 v[68:69], v[68:69], v[20:21]
    v_pk_add_f32 v[70:71], v[70:71], v[22:23]
    v_pk_add_f32 v[64:65], v[64:65], v[192:193]
    v_pk_add_f32 v[66:67], v[66:67], v[194:195]
    v_pk_add_f32 v[68:69], v[68:69], v[196:197]
    v_pk_add_f32 v[70:71], v[70:71], v[198:199]
    v_pk_mul_f32 v[80:81], v[64:65], s[60:61]
    v_pk_mul_f32 v[82:83], v[66:67], s[60:61]
    v_pk_mul_f32 v[84:85], v[68:69], s[60:61]
    v_pk_mul_f32 v[86:87], v[70:71], s[60:61]
    v_exp_f32 v80, v80
    v_exp_f32 v81, v81
    v_exp_f32 v82, v82
    v_exp_f32 v83, v83
    v_exp_f32 v84, v84
    v_exp_f32 v85, v85
    v_exp_f32 v86, v86
    v_exp_f32 v87, v87
    v_pk_add_f32 v[80:81], v[80:81], s[62:63]
    v_pk_add_f32 v[82:83], v[82:83], s[62:63]
    v_pk_add_f32 v[84:85], v[84:85], s[62:63]
    v_pk_add_f32 v[86:87], v[86:87], s[62:63]
    v_rcp_f32 v80, v80
    v_rcp_f32 v81, v81
    v_rcp_f32 v82, v82
    v_rcp_f32 v83, v83
    v_rcp_f32 v84, v84
    v_rcp_f32 v85, v85
    v_rcp_f32 v86, v86
    v_rcp_f32 v87, v87
    v_mul_f32 v64, v64, v128
    v_mul_f32 v65, v65, v132
    v_mul_f32 v66, v66, v129
    v_mul_f32 v67, v67, v133
    v_mul_f32 v68, v68, v130
    v_mul_f32 v69, v69, v134
    v_mul_f32 v70, v70, v131
    v_mul_f32 v71, v71, v135
    v_pk_fma_f32 v[80:81], v[80:81], v[64:65], v[176:177]
    v_pk_fma_f32 v[82:83], v[82:83], v[66:67], v[178:179]
    v_pk_fma_f32 v[84:85], v[84:85], v[68:69], v[180:181]
    v_pk_fma_f32 v[86:87], v[86:87], v[70:71], v[182:183]
    v_cvt_pk_bf16_f32 v96, v80, v81
    v_cvt_pk_bf16_f32 v97, v82, v83
    v_cvt_pk_bf16_f32 v98, v84, v85
    v_cvt_pk_bf16_f32 v99, v86, v87
    ds_write_b64 v236, v[96:97]
    ds_write_b64 v237, v[98:99]
    s_waitcnt lgkmcnt(2)
    v_pk_add_f32 v[200:201], v[200:201], v[216:217]
    v_pk_add_f32 v[202:203], v[202:203], v[218:219]
    v_pk_add_f32 v[204:205], v[204:205], v[220:221]
    v_pk_add_f32 v[206:207], v[206:207], v[222:223]
    v_pk_add_f32 v[72:73], v[72:73], v[24:25]
    v_pk_add_f32 v[74:75], v[74:75], v[26:27]
    v_pk_add_f32 v[76:77], v[76:77], v[28:29]
    v_pk_add_f32 v[78:79], v[78:79], v[30:31]
    v_pk_add_f32 v[72:73], v[72:73], v[200:201]
    v_pk_add_f32 v[74:75], v[74:75], v[202:203]
    v_pk_add_f32 v[76:77], v[76:77], v[204:205]
    v_pk_add_f32 v[78:79], v[78:79], v[206:207]
    v_pk_mul_f32 v[88:89], v[72:73], s[60:61]
    v_pk_mul_f32 v[90:91], v[74:75], s[60:61]
    v_pk_mul_f32 v[92:93], v[76:77], s[60:61]
    v_pk_mul_f32 v[94:95], v[78:79], s[60:61]
    v_exp_f32 v88, v88
    v_exp_f32 v89, v89
    v_exp_f32 v90, v90
    v_exp_f32 v91, v91
    v_exp_f32 v92, v92
    v_exp_f32 v93, v93
    v_exp_f32 v94, v94
    v_exp_f32 v95, v95
    v_pk_add_f32 v[88:89], v[88:89], s[62:63]
    v_pk_add_f32 v[90:91], v[90:91], s[62:63]
    v_pk_add_f32 v[92:93], v[92:93], s[62:63]
    v_pk_add_f32 v[94:95], v[94:95], s[62:63]
    v_rcp_f32 v88, v88
    v_rcp_f32 v89, v89
    v_rcp_f32 v90, v90
    v_rcp_f32 v91, v91
    v_rcp_f32 v92, v92
    v_rcp_f32 v93, v93
    v_rcp_f32 v94, v94
    v_rcp_f32 v95, v95
    v_mul_f32 v72, v72, v136
    v_mul_f32 v73, v73, v140
    v_mul_f32 v74, v74, v137
    v_mul_f32 v75, v75, v141
    v_mul_f32 v76, v76, v138
    v_mul_f32 v77, v77, v142
    v_mul_f32 v78, v78, v139
    v_mul_f32 v79, v79, v143
    v_pk_fma_f32 v[88:89], v[88:89], v[72:73], v[184:185]
    v_pk_fma_f32 v[90:91], v[90:91], v[74:75], v[186:187]
    v_pk_fma_f32 v[92:93], v[92:93], v[76:77], v[188:189]
    v_pk_fma_f32 v[94:95], v[94:95], v[78:79], v[190:191]
    v_cvt_pk_bf16_f32 v100, v88, v89
    v_cvt_pk_bf16_f32 v101, v90, v91
    v_cvt_pk_bf16_f32 v102, v92, v93
    v_cvt_pk_bf16_f32 v103, v94, v95
    ds_write_b64 v238, v[100:101]
    ds_write_b64 v239, v[102:103]
    s_waitcnt lgkmcnt(0)
    ds_read_b128 v[104:107], v240
    ds_read_b128 v[108:111], v240 offset:1024
    s_waitcnt lgkmcnt(1)
    buffer_store_dwordx4 v[104:107], v255, s[72:75], 0 offen
    s_waitcnt lgkmcnt(0)
    buffer_store_dwordx4 v[108:111], v255, s[72:75], s55 offen
L_end:
    s_endpgm
L_gslow:
    s_sleep 8
    buffer_load_dwordx4 v[144:147], v14, s[40:43], 0 offen offset:0 sc1
    buffer_load_dwordx4 v[148:151], v14, s[40:43], 0 offen offset:256 sc1
    buffer_load_dwordx2 v[152:153], v15, s[40:43], 0 offen offset:0 sc1
    buffer_load_dwordx2 v[154:155], v15, s[40:43], 0 offen offset:1024 sc1
    buffer_load_dwordx2 v[156:157], v17, s[40:43], 0 offen offset:0 sc1
    buffer_load_dwordx2 v[158:159], v17, s[40:43], 0 offen offset:1024 sc1
    s_waitcnt vmcnt(0)
    s_sub_u32 s56, s56, 1
    s_cbranch_scc0 L_gchk
    s_branch L_gok
L_pslow_m:
    buffer_load_dword v3, v63, s[40:43], 0 offen sc1
    s_sleep 5
L_poll_m:
    buffer_load_dword v4, v63, s[40:43], 0 offen sc1
    s_waitcnt vmcnt(1)
    v_cmp_ne_u32 vcc, s47, v3
    s_cbranch_vccz L_go_m
    s_sleep 2
    buffer_load_dword v3, v63, s[40:43], 0 offen sc1
    s_waitcnt vmcnt(1)
    v_cmp_ne_u32 vcc, s47, v4
    s_cbranch_vccz L_go_m
    s_sleep 2
    s_sub_u32 s56, s56, 1
    s_cbranch_scc0 L_poll_m
    s_branch L_go_m
L_uslow_m:
    s_sleep 8
    buffer_load_dword v176, v9, s[40:43], 0 offen sc1
    s_waitcnt vmcnt(0)
    s_sub_u32 s56, s56, 1
    s_cbranch_scc0 L_chk_m
    s_branch L_allset_m
L_ep0_m:
    v_lshrrev_b32 v4, 2, v0
    v_and_b32 v5, 3, v0
    v_mul_u32_u24 v5, 7, v5
    v_lshrrev_b32 v5, 1, v5
    v_lshl_add_u32 v4, v4, 4, v5
    v_lshlrev_b32 v4, 8, v4
    buffer_load_dword v6, v4, s[40:43], 0 offen offset:0 sc1
    buffer_load_dword v7, v4, s[40:43], 0 offen offset:256 sc1
    buffer_load_dword v8, v4, s[40:43], 0 offen offset:512 sc1
    buffer_load_dword v9, v4, s[40:43], 0 offen offset:768 sc1
    s_branch L_noep0_m
L_ep1_m:
    s_waitcnt vmcnt(2)
L_ep_m:
    v_xor_b32 v6, s47, v6
    v_xor_b32 v7, s47, v7
    v_xor_b32 v8, s47, v8
    v_xor_b32 v9, s47, v9
    v_or3_b32 v6, v6, v7, v8
    v_or_b32 v6, v6, v9
    v_cmp_ne_u32 vcc, 0, v6
    s_cbranch_vccz L_epok_m
    s_sleep 8
    buffer_load_dword v6, v4, s[40:43], 0 offen offset:0 sc1
    buffer_load_dword v7, v4, s[40:43], 0 offen offset:256 sc1
    buffer_load_dword v8, v4, s[40:43], 0 offen offset:512 sc1
    buffer_load_dword v9, v4, s[40:43], 0 offen offset:768 sc1
    s_waitcnt vmcnt(0)
    s_sub_u32 s56, s56, 1
    s_cbranch_scc0 L_ep_m
L_epok_m:
    v_mov_b32 v3, 73728
    s_mov_b64 exec, 1
    buffer_store_dword v2, v3, s[40:43], 0 offen sc1
    s_mov_b64 exec, -1
    s_branch L_noep_m
L_pslow_d:
    buffer_load_dword v3, v63, s[40:43], 0 offen sc1
    s_sleep 5
L_poll_d:
    buffer_load_dword v4, v63, s[40:43], 0 offen sc1
    s_waitcnt vmcnt(1)
    v_cmp_ne_u32 vcc, s47, v3
    s_cbranch_vccz L_go_d
    s_sleep 2
    buffer_load_dword v3, v63, s[40:43], 0 offen sc1
    s_waitcnt vmcnt(1)
    v_cmp_ne_u32 vcc, s47, v4
    s_cbranch_vccz L_go_d
    s_sleep 2
    s_sub_u32 s56, s56, 1
    s_cbranch_scc0 L_poll_d
    s_branch L_go_d
L_uslow_d:
    s_sleep 8
    buffer_load_dword v176, v9, s[40:43], 0 offen sc1
    s_waitcnt vmcnt(0)
    s_sub_u32 s56, s56, 1
    s_cbranch_scc0 L_chk_d
    s_branch L_allset_d
L_codeend:
.section .rodata,"a"
.p2align 6
.amdhsa_kernel recurrent_scan__spectral_fnet__mixer_channel_mlp__prompt_kernel
  .amdhsa_next_free_vgpr 512
  .amdhsa_next_free_sgpr 102
  .amdhsa_accum_offset 256
  .amdhsa_group_segment_fixed_size 0
  .amdhsa_kernarg_size 104
  .amdhsa_user_sgpr_count 2
  .amdhsa_user_sgpr_kernarg_segment_ptr 1
  .amdhsa_system_sgpr_workgroup_id_x 1
  .amdhsa_float_denorm_mode_32 3
.end_amdhsa_kernel
```
